```python
import torch

def _softmax(x, axis=-1):
    return torch.softmax(x, dim=axis)
def _gelu(x):
    return torch.nn.functional.gelu(x, approximate="tanh")
def _silu(x):
    return torch.nn.functional.silu(x)
def _sigmoid(x):
    return torch.sigmoid(x)
def _layernorm(x, axis=-1, eps=1e-5):
    m = x.mean(dim=axis, keepdim=True)
    v = x.var(dim=axis, keepdim=True, unbiased=False)
    return (x - m) / torch.sqrt(v + eps)
def _scatter_add(tgt, idx, src, axis=0):
    return tgt.clone().index_add_(axis, idx, src)
def _segment_sum(src, seg, n):
    out = torch.zeros((n,) + src.shape[1:], dtype=src.dtype)
    return out.index_add_(0, seg, src)
def _pad(x, pw):
    flat = tuple(v for pair in reversed(pw) for v in pair)
    return torch.nn.functional.pad(x, flat)

kernel_name = 'gated_mix__softmax_full_mha__ssm_conv_h3__prompt'

def setup_inputs():

    _w = (lambda a: (lambda t: t.to(torch.bfloat16) if t.is_floating_point() else t)(torch.as_tensor(a)))
    def _A_setup():
        B, S, D = 1, 2048, 640
        return {
            "x": _w((lambda *s: torch.randn(*s, dtype=torch.bfloat16) * 0.05)(B, S, D)),
            "wqkv": _w((lambda *s: torch.randn(*s, dtype=torch.bfloat16) * 0.8)(D, 3 * D)),
            "wo": _w((lambda *s: torch.randn(*s, dtype=torch.bfloat16) * 0.05)(D, D)),
        }
    _A_in = _A_setup()

    def _B_setup():
        B, S, D = 1, 2048, 640
        ks = 4
        return {
            "q": _w((lambda *s: torch.randn(*s, dtype=torch.bfloat16) * 0.05)(B, S, D)),
            "k": _w((lambda *s: torch.randn(*s, dtype=torch.bfloat16) * 0.8)(B, S, D)),
            "v": _w((lambda *s: torch.randn(*s, dtype=torch.bfloat16) * 0.4)(B, S, D)),
            "shift_k": _w((lambda *s: torch.randn(*s, dtype=torch.bfloat16) * 0.8)(D, ks) * 0.5),
            "ssm_k": _w((lambda *s: torch.randn(*s, dtype=torch.bfloat16) * 0.8)(D, S) * (1.0 / S ** 0.5)),
            "ssm_D": _w((lambda *s: torch.randn(*s, dtype=torch.bfloat16) * 0.4)(D)),
        }
    _B_in = _B_setup()

    return {
        "A_x": _A_in["x"],
        "A_wqkv": _A_in["wqkv"],
        "A_wo": _A_in["wo"],
        "B_q": _B_in["q"],
        "B_k": _B_in["k"],
        "B_v": _B_in["v"],
        "B_shift_k": _B_in["shift_k"],
        "B_ssm_k": _B_in["ssm_k"],
        "B_ssm_D": _B_in["ssm_D"],
        "gate_w": _w((lambda *s: torch.randn(*s, dtype=torch.bfloat16) * 0.05)(640) * 16.0),
    }

def reference(A_x, A_wqkv, A_wo, B_q, B_k, B_v, B_shift_k, B_ssm_k, B_ssm_D, gate_w):
    def _A_ref(x, wqkv, wo):
        B, S, D = x.shape
        H = 32; Dh = D // H
        qkv = (lambda x, *d: x.permute(*d))((x @ wqkv).reshape(B, S, 3, H, Dh), 2, 0, 3, 1, 4)
        q, k, v = qkv[0], qkv[1], qkv[2]
        scale = Dh ** -0.5
        scores = torch.einsum("bhqd,bhkd->bhqk", q, k) * scale
        p = _softmax(scores, axis=-1)
        o = torch.einsum("bhqk,bhkd->bhqd", p, v)
        return (lambda x, *d: x.permute(*d))(o, 0, 2, 1, 3).reshape(B, S, D) @ wo

    def _B_ref(q, k, v, shift_k, ssm_k, ssm_D):
        B, S, D = q.shape
        ks = shift_k.shape[-1]
        k_pad = _pad(k, ((0, 0), (ks - 1, 0), (0, 0)))
        k_shift = torch.zeros_like(k)
        for t in range(ks):
            k_shift = k_shift + k_pad[:, t:t + S, :] * shift_k[:, ks - 1 - t][None, None, :]
        kv = k_shift * v
        L = 2 * S
        kv_pad = _pad(kv, ((0, 0), (0, S), (0, 0)))
        kf_pad = _pad(ssm_k, ((0, 0), (0, S)))
        kv_f = (lambda x, axes=(-2,-1): torch.fft.rfft2(x.float(), dim=axes))(kv_pad[:, None, :, :], axes=(1, 2))
        kf_f = (lambda x, axes=(-2,-1): torch.fft.rfft2(x.float(), dim=axes))(kf_pad[:, None, :], axes=(1, 2))
        kf_f = (lambda x, *d: x.permute(*d))(kf_f, 1, 2, 0)
        y_f = kv_f * kf_f[None, :, :, :]
        y = (lambda x, s, axes=(-2,-1): torch.fft.irfft2(x, s=s, dim=axes).to(torch.bfloat16))(y_f, (1, L), axes=(1, 2))[:, 0, :S, :]
        y = y + kv * ssm_D[None, None, :]
        return q * y

    x = A_x
    g = _sigmoid((x * gate_w).sum(-1, keepdims=True))
    a = _A_ref(x, A_wqkv, A_wo)
    b = _B_ref(x, B_k, B_v, B_shift_k, B_ssm_k, B_ssm_D)
    return g * a + (1 - g) * b
```

```asm
; @launch kernel=proj_kernel grid=(256,1,1) block=(512,1,1) lds=131072
; @launch kernel=attn_kernel grid=(256,1,1) block=(768,1,1) lds=163840
.amdgcn_target "amdgcn-amd-amdhsa--gfx950"
.text
.globl proj_kernel
.p2align 8
.type proj_kernel,@function
proj_kernel:
  s_cmp_ge_u32 s2, 256
  s_cbranch_scc1 proj_kernel_end
  s_load_dwordx4 s[4:7], s[0:1], 0
  s_load_dwordx4 s[36:39], s[0:1], 32
  s_load_dwordx2 s[40:41], s[0:1], 48
  s_load_dwordx2 s[42:43], s[0:1], 72
  s_load_dwordx2 s[44:45], s[0:1], 96
  s_load_dwordx2 s[64:65], s[0:1], 16
  v_lshrrev_b32 v2, 6, v0
  v_and_b32 v1, 63, v0
  v_readfirstlane_b32 s3, v2
  s_and_b32 s46, s2, 1
  s_lshl_b32 s46, s46, 3
  s_bfe_u32 s48, s2, 0x30003
  s_add_u32 s46, s46, s48
  s_bfe_u32 s47, s2, 0x20001
  s_lshl_b32 s47, s47, 2
  s_lshr_b32 s48, s2, 6
  s_add_u32 s47, s47, s48
  s_waitcnt lgkmcnt(0)
  s_mov_b32 s8, s4
  s_and_b32 s9, s5, 0xffff
  s_mov_b32 s10, 2621440
  s_mov_b32 s11, 0x00020000
  s_mov_b32 s12, s6
  s_and_b32 s13, s7, 0xffff
  s_mov_b32 s14, 2457600
  s_mov_b32 s15, 0x00020000
  s_mov_b32 s16, s36
  s_and_b32 s17, s37, 0xffff
  s_mov_b32 s18, 2621440
  s_mov_b32 s19, 0x00020000
  s_mov_b32 s20, s38
  s_and_b32 s21, s39, 0xffff
  s_mov_b32 s22, 2621440
  s_mov_b32 s23, 0x00020000
  s_mov_b32 s24, s40
  s_and_b32 s25, s41, 0xffff
  s_mov_b32 s26, 5120
  s_mov_b32 s27, 0x00020000
  s_mov_b32 s28, s42
  s_and_b32 s29, s43, 0xffff
  s_mov_b32 s30, 1280
  s_mov_b32 s31, 0x00020000
  s_mov_b32 s32, s44
  s_and_b32 s33, s45, 0xffff
  s_mov_b32 s34, 17055744
  s_mov_b32 s35, 0x00020000
  s_mov_b32 s68, s64
  s_and_b32 s69, s65, 0xffff
  s_mov_b32 s70, 819200
  s_mov_b32 s71, 0x00020000
  s_mov_b32 s77, s3
  s_cmp_ge_u32 s3, 4
  s_cbranch_scc1 proj_kernel_loader
proj_kernel_compute:
  s_cmp_eq_u32 s46, 15
  s_cbranch_scc1 proj_kernel_wopack
  s_lshr_b32 s52, s3, 1
  s_and_b32 s53, s3, 1
  v_and_b32 v2, 3, v1
  v_bfe_u32 v3, v1, 4, 1
  v_bfe_u32 v4, v1, 2, 2
  v_lshrrev_b32 v5, 5, v1
  v_lshl_add_u32 v5, v5, 3, v4
  v_lshlrev_b32 v5, 8, v5
  v_lshl_add_u32 v5, v3, 5, v5
  v_lshl_add_u32 v5, v2, 3, v5
  s_lshl_b32 s54, s52, 1
  v_xor_b32 v6, s54, v4
  v_lshl_add_u32 v6, v6, 6, v5
  v_add_u32 v40, 16384, v6
  v_add_u32 v42, 81920, v6
  s_add_u32 s54, s54, 1
  v_xor_b32 v6, s54, v4
  v_lshl_add_u32 v6, v6, 6, v5
  v_add_u32 v41, 16384, v6
  v_add_u32 v43, 81920, v6
  v_and_b32 v2, 31, v1
  v_lshrrev_b32 v3, 5, v1
  v_bfe_u32 v4, v2, 1, 3
  v_xor_b32 v3, v3, v4
  v_lshlrev_b32 v3, 4, v3
  v_lshl_add_u32 v3, v2, 7, v3
  s_lshl_b32 s54, s53, 13
  v_add_u32 v3, s54, v3
  v_xor_b32 v44, 0, v3
  v_add_u32 v48, 65536, v44
  v_xor_b32 v45, 32, v3
  v_add_u32 v49, 65536, v45
  v_xor_b32 v46, 64, v3
  v_add_u32 v50, 65536, v46
  v_xor_b32 v47, 96, v3
  v_add_u32 v51, 65536, v47
  s_lshl_b32 s55, s47, 2
  s_lshl_b32 s56, s53, 1
  s_add_u32 s55, s55, s56
  s_and_b32 s62, s47, 7
  s_mul_i32 s62, s62, 21504
  s_lshr_b32 s63, s47, 3
  s_lshl_b32 s63, s63, 2
  s_add_u32 s63, s63, s56
  s_mul_i32 s63, s63, 2688
  s_add_u32 s62, s62, s63
  s_cmp_ge_u32 s46, 10
  s_cbranch_scc1 proj_kernel_vpath
  s_mul_i32 s57, s55, 1280
  s_add_u32 s57, s57, 5505024
  s_cmp_lt_u32 s46, 5
  s_cselect_b32 s57, s57, s62
  s_mov_b32 s56, 2688
  s_cselect_b32 s56, 1280, s56
  s_mov_b32 s61, 172032
  s_cselect_b32 s61, 81920, s61
  s_mov_b32 s58, 0x3ea52b5c
  s_cselect_b32 s58, s58, 1.0
  s_cselect_b32 s59, 0, 5
  s_sub_u32 s59, s46, s59
  s_lshl_b32 s59, s59, 5
  s_lshl_b32 s60, s52, 4
  s_add_u32 s59, s59, s60
  s_add_u32 s60, s57, s56
  v_and_b32 v2, 31, v1
  v_lshrrev_b32 v3, 5, v1
  v_add_u32 v3, s59, v3
  v_lshlrev_b32 v4, 4, v2
  v_lshlrev_b32 v5, 3, v2
  v_add_u32 v5, 1024, v5
  v_add_u32 v6, 0, v3
  v_mul_u32_u24 v7, 205, v6
  v_lshrrev_b32 v7, 10, v7
  v_mul_u32_u24 v52, 5, v7
  v_sub_u32 v52, v6, v52
  v_lshrrev_b32 v53, 1, v52
  v_lshl_add_u32 v53, v53, 9, v4
  v_and_b32 v54, 1, v52
  v_lshl_add_u32 v53, v54, 3, v53
  v_cmp_eq_u32 vcc, 4, v52
  v_mul_lo_u32 v7, v7, s61
  s_nop 0
  v_cndmask_b32 v53, v53, v5, vcc
  v_add_u32 v56, v53, v7
  v_add_u32 v6, 2, v3
  v_mul_u32_u24 v7, 205, v6
  v_lshrrev_b32 v7, 10, v7
  v_mul_u32_u24 v52, 5, v7
  v_sub_u32 v52, v6, v52
  v_lshrrev_b32 v53, 1, v52
  v_lshl_add_u32 v53, v53, 9, v4
  v_and_b32 v54, 1, v52
  v_lshl_add_u32 v53, v54, 3, v53
  v_cmp_eq_u32 vcc, 4, v52
  v_mul_lo_u32 v7, v7, s61
  s_nop 0
  v_cndmask_b32 v53, v53, v5, vcc
  v_add_u32 v57, v53, v7
  v_add_u32 v6, 4, v3
  v_mul_u32_u24 v7, 205, v6
  v_lshrrev_b32 v7, 10, v7
  v_mul_u32_u24 v52, 5, v7
  v_sub_u32 v52, v6, v52
  v_lshrrev_b32 v53, 1, v52
  v_lshl_add_u32 v53, v53, 9, v4
  v_and_b32 v54, 1, v52
  v_lshl_add_u32 v53, v54, 3, v53
  v_cmp_eq_u32 vcc, 4, v52
  v_mul_lo_u32 v7, v7, s61
  s_nop 0
  v_cndmask_b32 v53, v53, v5, vcc
  v_add_u32 v58, v53, v7
  v_add_u32 v6, 6, v3
  v_mul_u32_u24 v7, 205, v6
  v_lshrrev_b32 v7, 10, v7
  v_mul_u32_u24 v52, 5, v7
  v_sub_u32 v52, v6, v52
  v_lshrrev_b32 v53, 1, v52
  v_lshl_add_u32 v53, v53, 9, v4
  v_and_b32 v54, 1, v52
  v_lshl_add_u32 v53, v54, 3, v53
  v_cmp_eq_u32 vcc, 4, v52
  v_mul_lo_u32 v7, v7, s61
  s_nop 0
  v_cndmask_b32 v53, v53, v5, vcc
  v_add_u32 v59, v53, v7
  v_add_u32 v6, 8, v3
  v_mul_u32_u24 v7, 205, v6
  v_lshrrev_b32 v7, 10, v7
  v_mul_u32_u24 v52, 5, v7
  v_sub_u32 v52, v6, v52
  v_lshrrev_b32 v53, 1, v52
  v_lshl_add_u32 v53, v53, 9, v4
  v_and_b32 v54, 1, v52
  v_lshl_add_u32 v53, v54, 3, v53
  v_cmp_eq_u32 vcc, 4, v52
  v_mul_lo_u32 v7, v7, s61
  s_nop 0
  v_cndmask_b32 v53, v53, v5, vcc
  v_add_u32 v60, v53, v7
  v_add_u32 v6, 10, v3
  v_mul_u32_u24 v7, 205, v6
  v_lshrrev_b32 v7, 10, v7
  v_mul_u32_u24 v52, 5, v7
  v_sub_u32 v52, v6, v52
  v_lshrrev_b32 v53, 1, v52
  v_lshl_add_u32 v53, v53, 9, v4
  v_and_b32 v54, 1, v52
  v_lshl_add_u32 v53, v54, 3, v53
  v_cmp_eq_u32 vcc, 4, v52
  v_mul_lo_u32 v7, v7, s61
  s_nop 0
  v_cndmask_b32 v53, v53, v5, vcc
  v_add_u32 v61, v53, v7
  v_add_u32 v6, 12, v3
  v_mul_u32_u24 v7, 205, v6
  v_lshrrev_b32 v7, 10, v7
  v_mul_u32_u24 v52, 5, v7
  v_sub_u32 v52, v6, v52
  v_lshrrev_b32 v53, 1, v52
  v_lshl_add_u32 v53, v53, 9, v4
  v_and_b32 v54, 1, v52
  v_lshl_add_u32 v53, v54, 3, v53
  v_cmp_eq_u32 vcc, 4, v52
  v_mul_lo_u32 v7, v7, s61
  s_nop 0
  v_cndmask_b32 v53, v53, v5, vcc
  v_add_u32 v62, v53, v7
  v_add_u32 v6, 14, v3
  v_mul_u32_u24 v7, 205, v6
  v_lshrrev_b32 v7, 10, v7
  v_mul_u32_u24 v52, 5, v7
  v_sub_u32 v52, v6, v52
  v_lshrrev_b32 v53, 1, v52
  v_lshl_add_u32 v53, v53, 9, v4
  v_and_b32 v54, 1, v52
  v_lshl_add_u32 v53, v54, 3, v53
  v_cmp_eq_u32 vcc, 4, v52
  v_mul_lo_u32 v7, v7, s61
  s_nop 0
  v_cndmask_b32 v53, v53, v5, vcc
  v_add_u32 v63, v53, v7
  s_barrier
  ds_read_b64_tr_b16 v[8:9], v40 offset:0
  ds_read_b64_tr_b16 v[10:11], v40 offset:1024
  ds_read_b64_tr_b16 v[12:13], v41 offset:0
  ds_read_b64_tr_b16 v[14:15], v41 offset:1024
  ds_read_b128 v[16:19], v44 offset:0
  ds_read_b128 v[20:23], v44 offset:4096
  s_waitcnt lgkmcnt(0)
  ds_read_b64_tr_b16 v[24:25], v40 offset:4096
  ds_read_b64_tr_b16 v[26:27], v40 offset:5120
  v_mfma_f32_32x32x16_bf16 v[64:79], v[8:11], v[16:19], 0
  ds_read_b64_tr_b16 v[28:29], v41 offset:4096
  ds_read_b64_tr_b16 v[30:31], v41 offset:5120
  v_mfma_f32_32x32x16_bf16 v[80:95], v[8:11], v[20:23], 0
  ds_read_b128 v[32:35], v45 offset:0
  ds_read_b128 v[36:39], v45 offset:4096
  v_mfma_f32_32x32x16_bf16 v[96:111], v[12:15], v[16:19], 0
  v_mfma_f32_32x32x16_bf16 v[112:127], v[12:15], v[20:23], 0
  s_waitcnt lgkmcnt(0)
  ds_read_b64_tr_b16 v[8:9], v40 offset:8192
  ds_read_b64_tr_b16 v[10:11], v40 offset:9216
  v_mfma_f32_32x32x16_bf16 v[64:79], v[24:27], v[32:35], v[64:79]
  ds_read_b64_tr_b16 v[12:13], v41 offset:8192
  ds_read_b64_tr_b16 v[14:15], v41 offset:9216
  v_mfma_f32_32x32x16_bf16 v[80:95], v[24:27], v[36:39], v[80:95]
  ds_read_b128 v[16:19], v46 offset:0
  ds_read_b128 v[20:23], v46 offset:4096
  v_mfma_f32_32x32x16_bf16 v[96:111], v[28:31], v[32:35], v[96:111]
  v_mfma_f32_32x32x16_bf16 v[112:127], v[28:31], v[36:39], v[112:127]
  s_waitcnt lgkmcnt(0)
  ds_read_b64_tr_b16 v[24:25], v40 offset:12288
  ds_read_b64_tr_b16 v[26:27], v40 offset:13312
  v_mfma_f32_32x32x16_bf16 v[64:79], v[8:11], v[16:19], v[64:79]
  ds_read_b64_tr_b16 v[28:29], v41 offset:12288
  ds_read_b64_tr_b16 v[30:31], v41 offset:13312
  v_mfma_f32_32x32x16_bf16 v[80:95], v[8:11], v[20:23], v[80:95]
  ds_read_b128 v[32:35], v47 offset:0
  ds_read_b128 v[36:39], v47 offset:4096
  v_mfma_f32_32x32x16_bf16 v[96:111], v[12:15], v[16:19], v[96:111]
  v_mfma_f32_32x32x16_bf16 v[112:127], v[12:15], v[20:23], v[112:127]
  s_waitcnt lgkmcnt(0)
  s_barrier
  ds_read_b64_tr_b16 v[8:9], v40 offset:32768
  ds_read_b64_tr_b16 v[10:11], v40 offset:33792
  v_mfma_f32_32x32x16_bf16 v[64:79], v[24:27], v[32:35], v[64:79]
  ds_read_b64_tr_b16 v[12:13], v41 offset:32768
  ds_read_b64_tr_b16 v[14:15], v41 offset:33792
  v_mfma_f32_32x32x16_bf16 v[80:95], v[24:27], v[36:39], v[80:95]
  ds_read_b128 v[16:19], v44 offset:32768
  ds_read_b128 v[20:23], v44 offset:36864
  v_mfma_f32_32x32x16_bf16 v[96:111], v[28:31], v[32:35], v[96:111]
  v_mfma_f32_32x32x16_bf16 v[112:127], v[28:31], v[36:39], v[112:127]
  s_waitcnt lgkmcnt(0)
  ds_read_b64_tr_b16 v[24:25], v40 offset:36864
  ds_read_b64_tr_b16 v[26:27], v40 offset:37888
  v_mfma_f32_32x32x16_bf16 v[64:79], v[8:11], v[16:19], v[64:79]
  ds_read_b64_tr_b16 v[28:29], v41 offset:36864
  ds_read_b64_tr_b16 v[30:31], v41 offset:37888
  v_mfma_f32_32x32x16_bf16 v[80:95], v[8:11], v[20:23], v[80:95]
  ds_read_b128 v[32:35], v45 offset:32768
  ds_read_b128 v[36:39], v45 offset:36864
  v_mfma_f32_32x32x16_bf16 v[96:111], v[12:15], v[16:19], v[96:111]
  v_mfma_f32_32x32x16_bf16 v[112:127], v[12:15], v[20:23], v[112:127]
  s_waitcnt lgkmcnt(0)
  ds_read_b64_tr_b16 v[8:9], v40 offset:40960
  ds_read_b64_tr_b16 v[10:11], v40 offset:41984
  v_mfma_f32_32x32x16_bf16 v[64:79], v[24:27], v[32:35], v[64:79]
  ds_read_b64_tr_b16 v[12:13], v41 offset:40960
  ds_read_b64_tr_b16 v[14:15], v41 offset:41984
  v_mfma_f32_32x32x16_bf16 v[80:95], v[24:27], v[36:39], v[80:95]
  ds_read_b128 v[16:19], v46 offset:32768
  ds_read_b128 v[20:23], v46 offset:36864
  v_mfma_f32_32x32x16_bf16 v[96:111], v[28:31], v[32:35], v[96:111]
  v_mfma_f32_32x32x16_bf16 v[112:127], v[28:31], v[36:39], v[112:127]
  s_waitcnt lgkmcnt(0)
  ds_read_b64_tr_b16 v[24:25], v40 offset:45056
  ds_read_b64_tr_b16 v[26:27], v40 offset:46080
  v_mfma_f32_32x32x16_bf16 v[64:79], v[8:11], v[16:19], v[64:79]
  ds_read_b64_tr_b16 v[28:29], v41 offset:45056
  ds_read_b64_tr_b16 v[30:31], v41 offset:46080
  v_mfma_f32_32x32x16_bf16 v[80:95], v[8:11], v[20:23], v[80:95]
  ds_read_b128 v[32:35], v47 offset:32768
  ds_read_b128 v[36:39], v47 offset:36864
  v_mfma_f32_32x32x16_bf16 v[96:111], v[12:15], v[16:19], v[96:111]
  v_mfma_f32_32x32x16_bf16 v[112:127], v[12:15], v[20:23], v[112:127]
  s_waitcnt lgkmcnt(0)
  s_barrier
  ds_read_b64_tr_b16 v[8:9], v42 offset:0
  ds_read_b64_tr_b16 v[10:11], v42 offset:1024
  v_mfma_f32_32x32x16_bf16 v[64:79], v[24:27], v[32:35], v[64:79]
  ds_read_b64_tr_b16 v[12:13], v43 offset:0
  ds_read_b64_tr_b16 v[14:15], v43 offset:1024
  v_mfma_f32_32x32x16_bf16 v[80:95], v[24:27], v[36:39], v[80:95]
  ds_read_b128 v[16:19], v48 offset:0
  ds_read_b128 v[20:23], v48 offset:4096
  v_mfma_f32_32x32x16_bf16 v[96:111], v[28:31], v[32:35], v[96:111]
  v_mfma_f32_32x32x16_bf16 v[112:127], v[28:31], v[36:39], v[112:127]
  s_waitcnt lgkmcnt(0)
  ds_read_b64_tr_b16 v[24:25], v42 offset:4096
  ds_read_b64_tr_b16 v[26:27], v42 offset:5120
  v_mfma_f32_32x32x16_bf16 v[64:79], v[8:11], v[16:19], v[64:79]
  ds_read_b64_tr_b16 v[28:29], v43 offset:4096
  ds_read_b64_tr_b16 v[30:31], v43 offset:5120
  v_mfma_f32_32x32x16_bf16 v[80:95], v[8:11], v[20:23], v[80:95]
  ds_read_b128 v[32:35], v49 offset:0
  ds_read_b128 v[36:39], v49 offset:4096
  v_mfma_f32_32x32x16_bf16 v[96:111], v[12:15], v[16:19], v[96:111]
  v_mfma_f32_32x32x16_bf16 v[112:127], v[12:15], v[20:23], v[112:127]
  s_waitcnt lgkmcnt(0)
  ds_read_b64_tr_b16 v[8:9], v42 offset:8192
  ds_read_b64_tr_b16 v[10:11], v42 offset:9216
  v_mfma_f32_32x32x16_bf16 v[64:79], v[24:27], v[32:35], v[64:79]
  ds_read_b64_tr_b16 v[12:13], v43 offset:8192
  ds_read_b64_tr_b16 v[14:15], v43 offset:9216
  v_mfma_f32_32x32x16_bf16 v[80:95], v[24:27], v[36:39], v[80:95]
  ds_read_b128 v[16:19], v50 offset:0
  ds_read_b128 v[20:23], v50 offset:4096
  v_mfma_f32_32x32x16_bf16 v[96:111], v[28:31], v[32:35], v[96:111]
  v_mfma_f32_32x32x16_bf16 v[112:127], v[28:31], v[36:39], v[112:127]
  s_waitcnt lgkmcnt(0)
  ds_read_b64_tr_b16 v[24:25], v42 offset:12288
  ds_read_b64_tr_b16 v[26:27], v42 offset:13312
  v_mfma_f32_32x32x16_bf16 v[64:79], v[8:11], v[16:19], v[64:79]
  ds_read_b64_tr_b16 v[28:29], v43 offset:12288
  ds_read_b64_tr_b16 v[30:31], v43 offset:13312
  v_mfma_f32_32x32x16_bf16 v[80:95], v[8:11], v[20:23], v[80:95]
  ds_read_b128 v[32:35], v51 offset:0
  ds_read_b128 v[36:39], v51 offset:4096
  v_mfma_f32_32x32x16_bf16 v[96:111], v[12:15], v[16:19], v[96:111]
  v_mfma_f32_32x32x16_bf16 v[112:127], v[12:15], v[20:23], v[112:127]
  s_waitcnt lgkmcnt(0)
  s_barrier
  ds_read_b64_tr_b16 v[8:9], v42 offset:32768
  ds_read_b64_tr_b16 v[10:11], v42 offset:33792
  v_mfma_f32_32x32x16_bf16 v[64:79], v[24:27], v[32:35], v[64:79]
  ds_read_b64_tr_b16 v[12:13], v43 offset:32768
  ds_read_b64_tr_b16 v[14:15], v43 offset:33792
  v_mfma_f32_32x32x16_bf16 v[80:95], v[24:27], v[36:39], v[80:95]
  ds_read_b128 v[16:19], v48 offset:32768
  ds_read_b128 v[20:23], v48 offset:36864
  v_mfma_f32_32x32x16_bf16 v[96:111], v[28:31], v[32:35], v[96:111]
  v_mfma_f32_32x32x16_bf16 v[112:127], v[28:31], v[36:39], v[112:127]
  s_waitcnt lgkmcnt(0)
  ds_read_b64_tr_b16 v[24:25], v42 offset:36864
  ds_read_b64_tr_b16 v[26:27], v42 offset:37888
  v_mfma_f32_32x32x16_bf16 v[64:79], v[8:11], v[16:19], v[64:79]
  ds_read_b64_tr_b16 v[28:29], v43 offset:36864
  ds_read_b64_tr_b16 v[30:31], v43 offset:37888
  v_mfma_f32_32x32x16_bf16 v[80:95], v[8:11], v[20:23], v[80:95]
  ds_read_b128 v[32:35], v49 offset:32768
  ds_read_b128 v[36:39], v49 offset:36864
  v_mfma_f32_32x32x16_bf16 v[96:111], v[12:15], v[16:19], v[96:111]
  v_mfma_f32_32x32x16_bf16 v[112:127], v[12:15], v[20:23], v[112:127]
  s_waitcnt lgkmcnt(0)
  ds_read_b64_tr_b16 v[8:9], v42 offset:40960
  ds_read_b64_tr_b16 v[10:11], v42 offset:41984
  v_mfma_f32_32x32x16_bf16 v[64:79], v[24:27], v[32:35], v[64:79]
  ds_read_b64_tr_b16 v[12:13], v43 offset:40960
  ds_read_b64_tr_b16 v[14:15], v43 offset:41984
  v_mfma_f32_32x32x16_bf16 v[80:95], v[24:27], v[36:39], v[80:95]
  ds_read_b128 v[16:19], v50 offset:32768
  ds_read_b128 v[20:23], v50 offset:36864
  v_mfma_f32_32x32x16_bf16 v[96:111], v[28:31], v[32:35], v[96:111]
  v_mfma_f32_32x32x16_bf16 v[112:127], v[28:31], v[36:39], v[112:127]
  s_waitcnt lgkmcnt(0)
  ds_read_b64_tr_b16 v[24:25], v42 offset:45056
  ds_read_b64_tr_b16 v[26:27], v42 offset:46080
  v_mfma_f32_32x32x16_bf16 v[64:79], v[8:11], v[16:19], v[64:79]
  ds_read_b64_tr_b16 v[28:29], v43 offset:45056
  ds_read_b64_tr_b16 v[30:31], v43 offset:46080
  v_mfma_f32_32x32x16_bf16 v[80:95], v[8:11], v[20:23], v[80:95]
  ds_read_b128 v[32:35], v51 offset:32768
  ds_read_b128 v[36:39], v51 offset:36864
  v_mfma_f32_32x32x16_bf16 v[96:111], v[12:15], v[16:19], v[96:111]
  v_mfma_f32_32x32x16_bf16 v[112:127], v[12:15], v[20:23], v[112:127]
  s_waitcnt lgkmcnt(0)
  s_barrier
  ds_read_b64_tr_b16 v[8:9], v40 offset:0
  ds_read_b64_tr_b16 v[10:11], v40 offset:1024
  v_mfma_f32_32x32x16_bf16 v[64:79], v[24:27], v[32:35], v[64:79]
  ds_read_b64_tr_b16 v[12:13], v41 offset:0
  ds_read_b64_tr_b16 v[14:15], v41 offset:1024
  v_mfma_f32_32x32x16_bf16 v[80:95], v[24:27], v[36:39], v[80:95]
  ds_read_b128 v[16:19], v44 offset:0
  ds_read_b128 v[20:23], v44 offset:4096
  v_mfma_f32_32x32x16_bf16 v[96:111], v[28:31], v[32:35], v[96:111]
  v_mfma_f32_32x32x16_bf16 v[112:127], v[28:31], v[36:39], v[112:127]
  s_waitcnt lgkmcnt(0)
  ds_read_b64_tr_b16 v[24:25], v40 offset:4096
  ds_read_b64_tr_b16 v[26:27], v40 offset:5120
  v_mfma_f32_32x32x16_bf16 v[64:79], v[8:11], v[16:19], v[64:79]
  ds_read_b64_tr_b16 v[28:29], v41 offset:4096
  ds_read_b64_tr_b16 v[30:31], v41 offset:5120
  v_mfma_f32_32x32x16_bf16 v[80:95], v[8:11], v[20:23], v[80:95]
  ds_read_b128 v[32:35], v45 offset:0
  ds_read_b128 v[36:39], v45 offset:4096
  v_mfma_f32_32x32x16_bf16 v[96:111], v[12:15], v[16:19], v[96:111]
  v_mfma_f32_32x32x16_bf16 v[112:127], v[12:15], v[20:23], v[112:127]
  s_waitcnt lgkmcnt(0)
  ds_read_b64_tr_b16 v[8:9], v40 offset:8192
  ds_read_b64_tr_b16 v[10:11], v40 offset:9216
  v_mfma_f32_32x32x16_bf16 v[64:79], v[24:27], v[32:35], v[64:79]
  ds_read_b64_tr_b16 v[12:13], v41 offset:8192
  ds_read_b64_tr_b16 v[14:15], v41 offset:9216
  v_mfma_f32_32x32x16_bf16 v[80:95], v[24:27], v[36:39], v[80:95]
  ds_read_b128 v[16:19], v46 offset:0
  ds_read_b128 v[20:23], v46 offset:4096
  v_mfma_f32_32x32x16_bf16 v[96:111], v[28:31], v[32:35], v[96:111]
  v_mfma_f32_32x32x16_bf16 v[112:127], v[28:31], v[36:39], v[112:127]
  s_waitcnt lgkmcnt(0)
  ds_read_b64_tr_b16 v[24:25], v40 offset:12288
  ds_read_b64_tr_b16 v[26:27], v40 offset:13312
  v_mfma_f32_32x32x16_bf16 v[64:79], v[8:11], v[16:19], v[64:79]
  ds_read_b64_tr_b16 v[28:29], v41 offset:12288
  ds_read_b64_tr_b16 v[30:31], v41 offset:13312
  v_mfma_f32_32x32x16_bf16 v[80:95], v[8:11], v[20:23], v[80:95]
  ds_read_b128 v[32:35], v47 offset:0
  ds_read_b128 v[36:39], v47 offset:4096
  v_mfma_f32_32x32x16_bf16 v[96:111], v[12:15], v[16:19], v[96:111]
  v_mfma_f32_32x32x16_bf16 v[112:127], v[12:15], v[20:23], v[112:127]
  s_waitcnt lgkmcnt(0)
  s_barrier
  ds_read_b64_tr_b16 v[8:9], v40 offset:32768
  ds_read_b64_tr_b16 v[10:11], v40 offset:33792
  v_mfma_f32_32x32x16_bf16 v[64:79], v[24:27], v[32:35], v[64:79]
  ds_read_b64_tr_b16 v[12:13], v41 offset:32768
  ds_read_b64_tr_b16 v[14:15], v41 offset:33792
  v_mfma_f32_32x32x16_bf16 v[80:95], v[24:27], v[36:39], v[80:95]
  ds_read_b128 v[16:19], v44 offset:32768
  ds_read_b128 v[20:23], v44 offset:36864
  v_mfma_f32_32x32x16_bf16 v[96:111], v[28:31], v[32:35], v[96:111]
  v_mfma_f32_32x32x16_bf16 v[112:127], v[28:31], v[36:39], v[112:127]
  s_waitcnt lgkmcnt(0)
  ds_read_b64_tr_b16 v[24:25], v40 offset:36864
  ds_read_b64_tr_b16 v[26:27], v40 offset:37888
  v_mfma_f32_32x32x16_bf16 v[64:79], v[8:11], v[16:19], v[64:79]
  ds_read_b64_tr_b16 v[28:29], v41 offset:36864
  ds_read_b64_tr_b16 v[30:31], v41 offset:37888
  v_mfma_f32_32x32x16_bf16 v[80:95], v[8:11], v[20:23], v[80:95]
  ds_read_b128 v[32:35], v45 offset:32768
  ds_read_b128 v[36:39], v45 offset:36864
  v_mfma_f32_32x32x16_bf16 v[96:111], v[12:15], v[16:19], v[96:111]
  v_mfma_f32_32x32x16_bf16 v[112:127], v[12:15], v[20:23], v[112:127]
  s_waitcnt lgkmcnt(0)
  ds_read_b64_tr_b16 v[8:9], v40 offset:40960
  ds_read_b64_tr_b16 v[10:11], v40 offset:41984
  v_mfma_f32_32x32x16_bf16 v[64:79], v[24:27], v[32:35], v[64:79]
  ds_read_b64_tr_b16 v[12:13], v41 offset:40960
  ds_read_b64_tr_b16 v[14:15], v41 offset:41984
  v_mfma_f32_32x32x16_bf16 v[80:95], v[24:27], v[36:39], v[80:95]
  ds_read_b128 v[16:19], v46 offset:32768
  ds_read_b128 v[20:23], v46 offset:36864
  v_mfma_f32_32x32x16_bf16 v[96:111], v[28:31], v[32:35], v[96:111]
  v_mfma_f32_32x32x16_bf16 v[112:127], v[28:31], v[36:39], v[112:127]
  s_waitcnt lgkmcnt(0)
  ds_read_b64_tr_b16 v[24:25], v40 offset:45056
  ds_read_b64_tr_b16 v[26:27], v40 offset:46080
  v_mfma_f32_32x32x16_bf16 v[64:79], v[8:11], v[16:19], v[64:79]
  ds_read_b64_tr_b16 v[28:29], v41 offset:45056
  ds_read_b64_tr_b16 v[30:31], v41 offset:46080
  v_mfma_f32_32x32x16_bf16 v[80:95], v[8:11], v[20:23], v[80:95]
  ds_read_b128 v[32:35], v47 offset:32768
  ds_read_b128 v[36:39], v47 offset:36864
  v_mfma_f32_32x32x16_bf16 v[96:111], v[12:15], v[16:19], v[96:111]
  v_mfma_f32_32x32x16_bf16 v[112:127], v[12:15], v[20:23], v[112:127]
  s_waitcnt lgkmcnt(0)
  s_barrier
  ds_read_b64_tr_b16 v[8:9], v42 offset:0
  ds_read_b64_tr_b16 v[10:11], v42 offset:1024
  v_mfma_f32_32x32x16_bf16 v[64:79], v[24:27], v[32:35], v[64:79]
  ds_read_b64_tr_b16 v[12:13], v43 offset:0
  ds_read_b64_tr_b16 v[14:15], v43 offset:1024
  v_mfma_f32_32x32x16_bf16 v[80:95], v[24:27], v[36:39], v[80:95]
  ds_read_b128 v[16:19], v48 offset:0
  ds_read_b128 v[20:23], v48 offset:4096
  v_mfma_f32_32x32x16_bf16 v[96:111], v[28:31], v[32:35], v[96:111]
  v_mfma_f32_32x32x16_bf16 v[112:127], v[28:31], v[36:39], v[112:127]
  s_waitcnt lgkmcnt(0)
  ds_read_b64_tr_b16 v[24:25], v42 offset:4096
  ds_read_b64_tr_b16 v[26:27], v42 offset:5120
  v_mfma_f32_32x32x16_bf16 v[64:79], v[8:11], v[16:19], v[64:79]
  ds_read_b64_tr_b16 v[28:29], v43 offset:4096
  ds_read_b64_tr_b16 v[30:31], v43 offset:5120
  v_mfma_f32_32x32x16_bf16 v[80:95], v[8:11], v[20:23], v[80:95]
  ds_read_b128 v[32:35], v49 offset:0
  ds_read_b128 v[36:39], v49 offset:4096
  v_mfma_f32_32x32x16_bf16 v[96:111], v[12:15], v[16:19], v[96:111]
  v_mfma_f32_32x32x16_bf16 v[112:127], v[12:15], v[20:23], v[112:127]
  s_waitcnt lgkmcnt(0)
  ds_read_b64_tr_b16 v[8:9], v42 offset:8192
  ds_read_b64_tr_b16 v[10:11], v42 offset:9216
  v_mfma_f32_32x32x16_bf16 v[64:79], v[24:27], v[32:35], v[64:79]
  ds_read_b64_tr_b16 v[12:13], v43 offset:8192
  ds_read_b64_tr_b16 v[14:15], v43 offset:9216
  v_mfma_f32_32x32x16_bf16 v[80:95], v[24:27], v[36:39], v[80:95]
  ds_read_b128 v[16:19], v50 offset:0
  ds_read_b128 v[20:23], v50 offset:4096
  v_mfma_f32_32x32x16_bf16 v[96:111], v[28:31], v[32:35], v[96:111]
  v_mfma_f32_32x32x16_bf16 v[112:127], v[28:31], v[36:39], v[112:127]
  s_waitcnt lgkmcnt(0)
  ds_read_b64_tr_b16 v[24:25], v42 offset:12288
  ds_read_b64_tr_b16 v[26:27], v42 offset:13312
  v_mfma_f32_32x32x16_bf16 v[64:79], v[8:11], v[16:19], v[64:79]
  ds_read_b64_tr_b16 v[28:29], v43 offset:12288
  ds_read_b64_tr_b16 v[30:31], v43 offset:13312
  v_mfma_f32_32x32x16_bf16 v[80:95], v[8:11], v[20:23], v[80:95]
  ds_read_b128 v[32:35], v51 offset:0
  ds_read_b128 v[36:39], v51 offset:4096
  v_mfma_f32_32x32x16_bf16 v[96:111], v[12:15], v[16:19], v[96:111]
  v_mfma_f32_32x32x16_bf16 v[112:127], v[12:15], v[20:23], v[112:127]
  s_waitcnt lgkmcnt(0)
  s_barrier
  ds_read_b64_tr_b16 v[8:9], v42 offset:32768
  ds_read_b64_tr_b16 v[10:11], v42 offset:33792
  v_mfma_f32_32x32x16_bf16 v[64:79], v[24:27], v[32:35], v[64:79]
  ds_read_b64_tr_b16 v[12:13], v43 offset:32768
  ds_read_b64_tr_b16 v[14:15], v43 offset:33792
  v_mfma_f32_32x32x16_bf16 v[80:95], v[24:27], v[36:39], v[80:95]
  ds_read_b128 v[16:19], v48 offset:32768
  ds_read_b128 v[20:23], v48 offset:36864
  v_mfma_f32_32x32x16_bf16 v[96:111], v[28:31], v[32:35], v[96:111]
  v_mfma_f32_32x32x16_bf16 v[112:127], v[28:31], v[36:39], v[112:127]
  s_waitcnt lgkmcnt(0)
  ds_read_b64_tr_b16 v[24:25], v42 offset:36864
  ds_read_b64_tr_b16 v[26:27], v42 offset:37888
  v_mfma_f32_32x32x16_bf16 v[64:79], v[8:11], v[16:19], v[64:79]
  ds_read_b64_tr_b16 v[28:29], v43 offset:36864
  ds_read_b64_tr_b16 v[30:31], v43 offset:37888
  v_mfma_f32_32x32x16_bf16 v[80:95], v[8:11], v[20:23], v[80:95]
  ds_read_b128 v[32:35], v49 offset:32768
  ds_read_b128 v[36:39], v49 offset:36864
  v_mfma_f32_32x32x16_bf16 v[96:111], v[12:15], v[16:19], v[96:111]
  v_mfma_f32_32x32x16_bf16 v[112:127], v[12:15], v[20:23], v[112:127]
  s_waitcnt lgkmcnt(0)
  ds_read_b64_tr_b16 v[8:9], v42 offset:40960
  ds_read_b64_tr_b16 v[10:11], v42 offset:41984
  v_mfma_f32_32x32x16_bf16 v[64:79], v[24:27], v[32:35], v[64:79]
  ds_read_b64_tr_b16 v[12:13], v43 offset:40960
  ds_read_b64_tr_b16 v[14:15], v43 offset:41984
  v_mfma_f32_32x32x16_bf16 v[80:95], v[24:27], v[36:39], v[80:95]
  ds_read_b128 v[16:19], v50 offset:32768
  ds_read_b128 v[20:23], v50 offset:36864
  v_mfma_f32_32x32x16_bf16 v[96:111], v[28:31], v[32:35], v[96:111]
  v_mfma_f32_32x32x16_bf16 v[112:127], v[28:31], v[36:39], v[112:127]
  s_waitcnt lgkmcnt(0)
  ds_read_b64_tr_b16 v[24:25], v42 offset:45056
  ds_read_b64_tr_b16 v[26:27], v42 offset:46080
  v_mfma_f32_32x32x16_bf16 v[64:79], v[8:11], v[16:19], v[64:79]
  ds_read_b64_tr_b16 v[28:29], v43 offset:45056
  ds_read_b64_tr_b16 v[30:31], v43 offset:46080
  v_mfma_f32_32x32x16_bf16 v[80:95], v[8:11], v[20:23], v[80:95]
  ds_read_b128 v[32:35], v51 offset:32768
  ds_read_b128 v[36:39], v51 offset:36864
  v_mfma_f32_32x32x16_bf16 v[96:111], v[12:15], v[16:19], v[96:111]
  v_mfma_f32_32x32x16_bf16 v[112:127], v[12:15], v[20:23], v[112:127]
  s_waitcnt lgkmcnt(0)
  s_barrier
  ds_read_b64_tr_b16 v[8:9], v40 offset:0
  ds_read_b64_tr_b16 v[10:11], v40 offset:1024
  v_mfma_f32_32x32x16_bf16 v[64:79], v[24:27], v[32:35], v[64:79]
  ds_read_b64_tr_b16 v[12:13], v41 offset:0
  ds_read_b64_tr_b16 v[14:15], v41 offset:1024
  v_mfma_f32_32x32x16_bf16 v[80:95], v[24:27], v[36:39], v[80:95]
  ds_read_b128 v[16:19], v44 offset:0
  ds_read_b128 v[20:23], v44 offset:4096
  v_mfma_f32_32x32x16_bf16 v[96:111], v[28:31], v[32:35], v[96:111]
  v_mfma_f32_32x32x16_bf16 v[112:127], v[28:31], v[36:39], v[112:127]
  s_waitcnt lgkmcnt(0)
  ds_read_b64_tr_b16 v[24:25], v40 offset:4096
  ds_read_b64_tr_b16 v[26:27], v40 offset:5120
  v_mfma_f32_32x32x16_bf16 v[64:79], v[8:11], v[16:19], v[64:79]
  ds_read_b64_tr_b16 v[28:29], v41 offset:4096
  ds_read_b64_tr_b16 v[30:31], v41 offset:5120
  v_mfma_f32_32x32x16_bf16 v[80:95], v[8:11], v[20:23], v[80:95]
  ds_read_b128 v[32:35], v45 offset:0
  ds_read_b128 v[36:39], v45 offset:4096
  v_mfma_f32_32x32x16_bf16 v[96:111], v[12:15], v[16:19], v[96:111]
  v_mfma_f32_32x32x16_bf16 v[112:127], v[12:15], v[20:23], v[112:127]
  s_waitcnt lgkmcnt(0)
  ds_read_b64_tr_b16 v[8:9], v40 offset:8192
  ds_read_b64_tr_b16 v[10:11], v40 offset:9216
  v_mfma_f32_32x32x16_bf16 v[64:79], v[24:27], v[32:35], v[64:79]
  ds_read_b64_tr_b16 v[12:13], v41 offset:8192
  ds_read_b64_tr_b16 v[14:15], v41 offset:9216
  v_mfma_f32_32x32x16_bf16 v[80:95], v[24:27], v[36:39], v[80:95]
  ds_read_b128 v[16:19], v46 offset:0
  ds_read_b128 v[20:23], v46 offset:4096
  v_mfma_f32_32x32x16_bf16 v[96:111], v[28:31], v[32:35], v[96:111]
  v_mfma_f32_32x32x16_bf16 v[112:127], v[28:31], v[36:39], v[112:127]
  s_waitcnt lgkmcnt(0)
  ds_read_b64_tr_b16 v[24:25], v40 offset:12288
  ds_read_b64_tr_b16 v[26:27], v40 offset:13312
  v_mfma_f32_32x32x16_bf16 v[64:79], v[8:11], v[16:19], v[64:79]
  ds_read_b64_tr_b16 v[28:29], v41 offset:12288
  ds_read_b64_tr_b16 v[30:31], v41 offset:13312
  v_mfma_f32_32x32x16_bf16 v[80:95], v[8:11], v[20:23], v[80:95]
  ds_read_b128 v[32:35], v47 offset:0
  ds_read_b128 v[36:39], v47 offset:4096
  v_mfma_f32_32x32x16_bf16 v[96:111], v[12:15], v[16:19], v[96:111]
  v_mfma_f32_32x32x16_bf16 v[112:127], v[12:15], v[20:23], v[112:127]
  s_waitcnt lgkmcnt(0)
  s_barrier
  ds_read_b64_tr_b16 v[8:9], v40 offset:32768
  ds_read_b64_tr_b16 v[10:11], v40 offset:33792
  v_mfma_f32_32x32x16_bf16 v[64:79], v[24:27], v[32:35], v[64:79]
  ds_read_b64_tr_b16 v[12:13], v41 offset:32768
  ds_read_b64_tr_b16 v[14:15], v41 offset:33792
  v_mfma_f32_32x32x16_bf16 v[80:95], v[24:27], v[36:39], v[80:95]
  ds_read_b128 v[16:19], v44 offset:32768
  ds_read_b128 v[20:23], v44 offset:36864
  v_mfma_f32_32x32x16_bf16 v[96:111], v[28:31], v[32:35], v[96:111]
  v_mfma_f32_32x32x16_bf16 v[112:127], v[28:31], v[36:39], v[112:127]
  s_waitcnt lgkmcnt(0)
  ds_read_b64_tr_b16 v[24:25], v40 offset:36864
  ds_read_b64_tr_b16 v[26:27], v40 offset:37888
  v_mfma_f32_32x32x16_bf16 v[64:79], v[8:11], v[16:19], v[64:79]
  ds_read_b64_tr_b16 v[28:29], v41 offset:36864
  ds_read_b64_tr_b16 v[30:31], v41 offset:37888
  v_mfma_f32_32x32x16_bf16 v[80:95], v[8:11], v[20:23], v[80:95]
  ds_read_b128 v[32:35], v45 offset:32768
  ds_read_b128 v[36:39], v45 offset:36864
  v_mfma_f32_32x32x16_bf16 v[96:111], v[12:15], v[16:19], v[96:111]
  v_mfma_f32_32x32x16_bf16 v[112:127], v[12:15], v[20:23], v[112:127]
  s_waitcnt lgkmcnt(0)
  ds_read_b64_tr_b16 v[8:9], v40 offset:40960
  ds_read_b64_tr_b16 v[10:11], v40 offset:41984
  v_mfma_f32_32x32x16_bf16 v[64:79], v[24:27], v[32:35], v[64:79]
  ds_read_b64_tr_b16 v[12:13], v41 offset:40960
  ds_read_b64_tr_b16 v[14:15], v41 offset:41984
  v_mfma_f32_32x32x16_bf16 v[80:95], v[24:27], v[36:39], v[80:95]
  ds_read_b128 v[16:19], v46 offset:32768
  ds_read_b128 v[20:23], v46 offset:36864
  v_mfma_f32_32x32x16_bf16 v[96:111], v[28:31], v[32:35], v[96:111]
  v_mfma_f32_32x32x16_bf16 v[112:127], v[28:31], v[36:39], v[112:127]
  s_waitcnt lgkmcnt(0)
  ds_read_b64_tr_b16 v[24:25], v40 offset:45056
  ds_read_b64_tr_b16 v[26:27], v40 offset:46080
  v_mfma_f32_32x32x16_bf16 v[64:79], v[8:11], v[16:19], v[64:79]
  ds_read_b64_tr_b16 v[28:29], v41 offset:45056
  ds_read_b64_tr_b16 v[30:31], v41 offset:46080
  v_mfma_f32_32x32x16_bf16 v[80:95], v[8:11], v[20:23], v[80:95]
  ds_read_b128 v[32:35], v47 offset:32768
  ds_read_b128 v[36:39], v47 offset:36864
  v_mfma_f32_32x32x16_bf16 v[96:111], v[12:15], v[16:19], v[96:111]
  v_mfma_f32_32x32x16_bf16 v[112:127], v[12:15], v[20:23], v[112:127]
  s_waitcnt lgkmcnt(0)
  v_mfma_f32_32x32x16_bf16 v[64:79], v[24:27], v[32:35], v[64:79]
  v_mfma_f32_32x32x16_bf16 v[80:95], v[24:27], v[36:39], v[80:95]
  v_mfma_f32_32x32x16_bf16 v[96:111], v[28:31], v[32:35], v[96:111]
  v_mfma_f32_32x32x16_bf16 v[112:127], v[28:31], v[36:39], v[112:127]
  s_nop 8
  v_mul_f32 v64, s58, v64
  v_mul_f32 v65, s58, v65
  v_mul_f32 v66, s58, v66
  v_mul_f32 v67, s58, v67
  v_cvt_pk_bf16_f32 v20, v64, v65
  v_cvt_pk_bf16_f32 v21, v66, v67
  buffer_store_dwordx2 v[20:21], v56, s[32:35], s57 offen
  v_mul_f32 v80, s58, v80
  v_mul_f32 v81, s58, v81
  v_mul_f32 v82, s58, v82
  v_mul_f32 v83, s58, v83
  v_cvt_pk_bf16_f32 v22, v80, v81
  v_cvt_pk_bf16_f32 v23, v82, v83
  buffer_store_dwordx2 v[22:23], v56, s[32:35], s60 offen
  v_mul_f32 v68, s58, v68
  v_mul_f32 v69, s58, v69
  v_mul_f32 v70, s58, v70
  v_mul_f32 v71, s58, v71
  v_cvt_pk_bf16_f32 v24, v68, v69
  v_cvt_pk_bf16_f32 v25, v70, v71
  buffer_store_dwordx2 v[24:25], v57, s[32:35], s57 offen
  v_mul_f32 v84, s58, v84
  v_mul_f32 v85, s58, v85
  v_mul_f32 v86, s58, v86
  v_mul_f32 v87, s58, v87
  v_cvt_pk_bf16_f32 v26, v84, v85
  v_cvt_pk_bf16_f32 v27, v86, v87
  buffer_store_dwordx2 v[26:27], v57, s[32:35], s60 offen
  v_mul_f32 v72, s58, v72
  v_mul_f32 v73, s58, v73
  v_mul_f32 v74, s58, v74
  v_mul_f32 v75, s58, v75
  v_cvt_pk_bf16_f32 v28, v72, v73
  v_cvt_pk_bf16_f32 v29, v74, v75
  buffer_store_dwordx2 v[28:29], v58, s[32:35], s57 offen
  v_mul_f32 v88, s58, v88
  v_mul_f32 v89, s58, v89
  v_mul_f32 v90, s58, v90
  v_mul_f32 v91, s58, v91
  v_cvt_pk_bf16_f32 v30, v88, v89
  v_cvt_pk_bf16_f32 v31, v90, v91
  buffer_store_dwordx2 v[30:31], v58, s[32:35], s60 offen
  v_mul_f32 v76, s58, v76
  v_mul_f32 v77, s58, v77
  v_mul_f32 v78, s58, v78
  v_mul_f32 v79, s58, v79
  v_cvt_pk_bf16_f32 v32, v76, v77
  v_cvt_pk_bf16_f32 v33, v78, v79
  buffer_store_dwordx2 v[32:33], v59, s[32:35], s57 offen
  v_mul_f32 v92, s58, v92
  v_mul_f32 v93, s58, v93
  v_mul_f32 v94, s58, v94
  v_mul_f32 v95, s58, v95
  v_cvt_pk_bf16_f32 v34, v92, v93
  v_cvt_pk_bf16_f32 v35, v94, v95
  buffer_store_dwordx2 v[34:35], v59, s[32:35], s60 offen
  v_mul_f32 v96, s58, v96
  v_mul_f32 v97, s58, v97
  v_mul_f32 v98, s58, v98
  v_mul_f32 v99, s58, v99
  v_cvt_pk_bf16_f32 v20, v96, v97
  v_cvt_pk_bf16_f32 v21, v98, v99
  buffer_store_dwordx2 v[20:21], v60, s[32:35], s57 offen
  v_mul_f32 v112, s58, v112
  v_mul_f32 v113, s58, v113
  v_mul_f32 v114, s58, v114
  v_mul_f32 v115, s58, v115
  v_cvt_pk_bf16_f32 v22, v112, v113
  v_cvt_pk_bf16_f32 v23, v114, v115
  buffer_store_dwordx2 v[22:23], v60, s[32:35], s60 offen
  v_mul_f32 v100, s58, v100
  v_mul_f32 v101, s58, v101
  v_mul_f32 v102, s58, v102
  v_mul_f32 v103, s58, v103
  v_cvt_pk_bf16_f32 v24, v100, v101
  v_cvt_pk_bf16_f32 v25, v102, v103
  buffer_store_dwordx2 v[24:25], v61, s[32:35], s57 offen
  v_mul_f32 v116, s58, v116
  v_mul_f32 v117, s58, v117
  v_mul_f32 v118, s58, v118
  v_mul_f32 v119, s58, v119
  v_cvt_pk_bf16_f32 v26, v116, v117
  v_cvt_pk_bf16_f32 v27, v118, v119
  buffer_store_dwordx2 v[26:27], v61, s[32:35], s60 offen
  v_mul_f32 v104, s58, v104
  v_mul_f32 v105, s58, v105
  v_mul_f32 v106, s58, v106
  v_mul_f32 v107, s58, v107
  v_cvt_pk_bf16_f32 v28, v104, v105
  v_cvt_pk_bf16_f32 v29, v106, v107
  buffer_store_dwordx2 v[28:29], v62, s[32:35], s57 offen
  v_mul_f32 v120, s58, v120
  v_mul_f32 v121, s58, v121
  v_mul_f32 v122, s58, v122
  v_mul_f32 v123, s58, v123
  v_cvt_pk_bf16_f32 v30, v120, v121
  v_cvt_pk_bf16_f32 v31, v122, v123
  buffer_store_dwordx2 v[30:31], v62, s[32:35], s60 offen
  v_mul_f32 v108, s58, v108
  v_mul_f32 v109, s58, v109
  v_mul_f32 v110, s58, v110
  v_mul_f32 v111, s58, v111
  v_cvt_pk_bf16_f32 v32, v108, v109
  v_cvt_pk_bf16_f32 v33, v110, v111
  buffer_store_dwordx2 v[32:33], v63, s[32:35], s57 offen
  v_mul_f32 v124, s58, v124
  v_mul_f32 v125, s58, v125
  v_mul_f32 v126, s58, v126
  v_mul_f32 v127, s58, v127
  v_cvt_pk_bf16_f32 v34, v124, v125
  v_cvt_pk_bf16_f32 v35, v126, v127
  buffer_store_dwordx2 v[34:35], v63, s[32:35], s60 offen
  s_endpgm
proj_kernel_vpath:
  s_sub_u32 s59, s46, 10
  s_lshl_b32 s59, s59, 7
  s_lshl_b32 s60, s52, 6
  s_add_u32 s59, s59, s60
  s_add_u32 s57, s62, 1344
  s_add_u32 s60, s57, 2688
  s_mov_b32 s61, 171712
  v_and_b32 v2, 31, v1
  v_add_u32 v2, s59, v2
  v_lshrrev_b32 v3, 5, v1
  v_mul_u32_u24 v3, 336, v3
  v_add_u32 v6, 0, v2
  v_mul_u32_u24 v7, 3277, v6
  v_lshrrev_b32 v7, 16, v7
  v_mul_lo_u32 v7, v7, s61
  v_lshl_add_u32 v7, v6, 4, v7
  v_add_u32 v56, v7, v3
  v_add_u32 v6, 32, v2
  v_mul_u32_u24 v7, 3277, v6
  v_lshrrev_b32 v7, 16, v7
  v_mul_lo_u32 v7, v7, s61
  v_lshl_add_u32 v7, v6, 4, v7
  v_add_u32 v57, v7, v3
  s_barrier
  ds_read_b64_tr_b16 v[8:9], v40 offset:0
  ds_read_b64_tr_b16 v[10:11], v40 offset:1024
  ds_read_b64_tr_b16 v[12:13], v41 offset:0
  ds_read_b64_tr_b16 v[14:15], v41 offset:1024
  ds_read_b128 v[16:19], v44 offset:0
  ds_read_b128 v[20:23], v44 offset:4096
  s_waitcnt lgkmcnt(0)
  ds_read_b64_tr_b16 v[24:25], v40 offset:4096
  ds_read_b64_tr_b16 v[26:27], v40 offset:5120
  v_mfma_f32_32x32x16_bf16 v[64:79], v[16:19], v[8:11], 0
  ds_read_b64_tr_b16 v[28:29], v41 offset:4096
  ds_read_b64_tr_b16 v[30:31], v41 offset:5120
  v_mfma_f32_32x32x16_bf16 v[80:95], v[20:23], v[8:11], 0
  ds_read_b128 v[32:35], v45 offset:0
  ds_read_b128 v[36:39], v45 offset:4096
  v_mfma_f32_32x32x16_bf16 v[96:111], v[16:19], v[12:15], 0
  v_mfma_f32_32x32x16_bf16 v[112:127], v[20:23], v[12:15], 0
  s_waitcnt lgkmcnt(0)
  ds_read_b64_tr_b16 v[8:9], v40 offset:8192
  ds_read_b64_tr_b16 v[10:11], v40 offset:9216
  v_mfma_f32_32x32x16_bf16 v[64:79], v[32:35], v[24:27], v[64:79]
  ds_read_b64_tr_b16 v[12:13], v41 offset:8192
  ds_read_b64_tr_b16 v[14:15], v41 offset:9216
  v_mfma_f32_32x32x16_bf16 v[80:95], v[36:39], v[24:27], v[80:95]
  ds_read_b128 v[16:19], v46 offset:0
  ds_read_b128 v[20:23], v46 offset:4096
  v_mfma_f32_32x32x16_bf16 v[96:111], v[32:35], v[28:31], v[96:111]
  v_mfma_f32_32x32x16_bf16 v[112:127], v[36:39], v[28:31], v[112:127]
  s_waitcnt lgkmcnt(0)
  ds_read_b64_tr_b16 v[24:25], v40 offset:12288
  ds_read_b64_tr_b16 v[26:27], v40 offset:13312
  v_mfma_f32_32x32x16_bf16 v[64:79], v[16:19], v[8:11], v[64:79]
  ds_read_b64_tr_b16 v[28:29], v41 offset:12288
  ds_read_b64_tr_b16 v[30:31], v41 offset:13312
  v_mfma_f32_32x32x16_bf16 v[80:95], v[20:23], v[8:11], v[80:95]
  ds_read_b128 v[32:35], v47 offset:0
  ds_read_b128 v[36:39], v47 offset:4096
  v_mfma_f32_32x32x16_bf16 v[96:111], v[16:19], v[12:15], v[96:111]
  v_mfma_f32_32x32x16_bf16 v[112:127], v[20:23], v[12:15], v[112:127]
  s_waitcnt lgkmcnt(0)
  s_barrier
  ds_read_b64_tr_b16 v[8:9], v40 offset:32768
  ds_read_b64_tr_b16 v[10:11], v40 offset:33792
  v_mfma_f32_32x32x16_bf16 v[64:79], v[32:35], v[24:27], v[64:79]
  ds_read_b64_tr_b16 v[12:13], v41 offset:32768
  ds_read_b64_tr_b16 v[14:15], v41 offset:33792
  v_mfma_f32_32x32x16_bf16 v[80:95], v[36:39], v[24:27], v[80:95]
  ds_read_b128 v[16:19], v44 offset:32768
  ds_read_b128 v[20:23], v44 offset:36864
  v_mfma_f32_32x32x16_bf16 v[96:111], v[32:35], v[28:31], v[96:111]
  v_mfma_f32_32x32x16_bf16 v[112:127], v[36:39], v[28:31], v[112:127]
  s_waitcnt lgkmcnt(0)
  ds_read_b64_tr_b16 v[24:25], v40 offset:36864
  ds_read_b64_tr_b16 v[26:27], v40 offset:37888
  v_mfma_f32_32x32x16_bf16 v[64:79], v[16:19], v[8:11], v[64:79]
  ds_read_b64_tr_b16 v[28:29], v41 offset:36864
  ds_read_b64_tr_b16 v[30:31], v41 offset:37888
  v_mfma_f32_32x32x16_bf16 v[80:95], v[20:23], v[8:11], v[80:95]
  ds_read_b128 v[32:35], v45 offset:32768
  ds_read_b128 v[36:39], v45 offset:36864
  v_mfma_f32_32x32x16_bf16 v[96:111], v[16:19], v[12:15], v[96:111]
  v_mfma_f32_32x32x16_bf16 v[112:127], v[20:23], v[12:15], v[112:127]
  s_waitcnt lgkmcnt(0)
  ds_read_b64_tr_b16 v[8:9], v40 offset:40960
  ds_read_b64_tr_b16 v[10:11], v40 offset:41984
  v_mfma_f32_32x32x16_bf16 v[64:79], v[32:35], v[24:27], v[64:79]
  ds_read_b64_tr_b16 v[12:13], v41 offset:40960
  ds_read_b64_tr_b16 v[14:15], v41 offset:41984
  v_mfma_f32_32x32x16_bf16 v[80:95], v[36:39], v[24:27], v[80:95]
  ds_read_b128 v[16:19], v46 offset:32768
  ds_read_b128 v[20:23], v46 offset:36864
  v_mfma_f32_32x32x16_bf16 v[96:111], v[32:35], v[28:31], v[96:111]
  v_mfma_f32_32x32x16_bf16 v[112:127], v[36:39], v[28:31], v[112:127]
  s_waitcnt lgkmcnt(0)
  ds_read_b64_tr_b16 v[24:25], v40 offset:45056
  ds_read_b64_tr_b16 v[26:27], v40 offset:46080
  v_mfma_f32_32x32x16_bf16 v[64:79], v[16:19], v[8:11], v[64:79]
  ds_read_b64_tr_b16 v[28:29], v41 offset:45056
  ds_read_b64_tr_b16 v[30:31], v41 offset:46080
  v_mfma_f32_32x32x16_bf16 v[80:95], v[20:23], v[8:11], v[80:95]
  ds_read_b128 v[32:35], v47 offset:32768
  ds_read_b128 v[36:39], v47 offset:36864
  v_mfma_f32_32x32x16_bf16 v[96:111], v[16:19], v[12:15], v[96:111]
  v_mfma_f32_32x32x16_bf16 v[112:127], v[20:23], v[12:15], v[112:127]
  s_waitcnt lgkmcnt(0)
  s_barrier
  ds_read_b64_tr_b16 v[8:9], v42 offset:0
  ds_read_b64_tr_b16 v[10:11], v42 offset:1024
  v_mfma_f32_32x32x16_bf16 v[64:79], v[32:35], v[24:27], v[64:79]
  ds_read_b64_tr_b16 v[12:13], v43 offset:0
  ds_read_b64_tr_b16 v[14:15], v43 offset:1024
  v_mfma_f32_32x32x16_bf16 v[80:95], v[36:39], v[24:27], v[80:95]
  ds_read_b128 v[16:19], v48 offset:0
  ds_read_b128 v[20:23], v48 offset:4096
  v_mfma_f32_32x32x16_bf16 v[96:111], v[32:35], v[28:31], v[96:111]
  v_mfma_f32_32x32x16_bf16 v[112:127], v[36:39], v[28:31], v[112:127]
  s_waitcnt lgkmcnt(0)
  ds_read_b64_tr_b16 v[24:25], v42 offset:4096
  ds_read_b64_tr_b16 v[26:27], v42 offset:5120
  v_mfma_f32_32x32x16_bf16 v[64:79], v[16:19], v[8:11], v[64:79]
  ds_read_b64_tr_b16 v[28:29], v43 offset:4096
  ds_read_b64_tr_b16 v[30:31], v43 offset:5120
  v_mfma_f32_32x32x16_bf16 v[80:95], v[20:23], v[8:11], v[80:95]
  ds_read_b128 v[32:35], v49 offset:0
  ds_read_b128 v[36:39], v49 offset:4096
  v_mfma_f32_32x32x16_bf16 v[96:111], v[16:19], v[12:15], v[96:111]
  v_mfma_f32_32x32x16_bf16 v[112:127], v[20:23], v[12:15], v[112:127]
  s_waitcnt lgkmcnt(0)
  ds_read_b64_tr_b16 v[8:9], v42 offset:8192
  ds_read_b64_tr_b16 v[10:11], v42 offset:9216
  v_mfma_f32_32x32x16_bf16 v[64:79], v[32:35], v[24:27], v[64:79]
  ds_read_b64_tr_b16 v[12:13], v43 offset:8192
  ds_read_b64_tr_b16 v[14:15], v43 offset:9216
  v_mfma_f32_32x32x16_bf16 v[80:95], v[36:39], v[24:27], v[80:95]
  ds_read_b128 v[16:19], v50 offset:0
  ds_read_b128 v[20:23], v50 offset:4096
  v_mfma_f32_32x32x16_bf16 v[96:111], v[32:35], v[28:31], v[96:111]
  v_mfma_f32_32x32x16_bf16 v[112:127], v[36:39], v[28:31], v[112:127]
  s_waitcnt lgkmcnt(0)
  ds_read_b64_tr_b16 v[24:25], v42 offset:12288
  ds_read_b64_tr_b16 v[26:27], v42 offset:13312
  v_mfma_f32_32x32x16_bf16 v[64:79], v[16:19], v[8:11], v[64:79]
  ds_read_b64_tr_b16 v[28:29], v43 offset:12288
  ds_read_b64_tr_b16 v[30:31], v43 offset:13312
  v_mfma_f32_32x32x16_bf16 v[80:95], v[20:23], v[8:11], v[80:95]
  ds_read_b128 v[32:35], v51 offset:0
  ds_read_b128 v[36:39], v51 offset:4096
  v_mfma_f32_32x32x16_bf16 v[96:111], v[16:19], v[12:15], v[96:111]
  v_mfma_f32_32x32x16_bf16 v[112:127], v[20:23], v[12:15], v[112:127]
  s_waitcnt lgkmcnt(0)
  s_barrier
  ds_read_b64_tr_b16 v[8:9], v42 offset:32768
  ds_read_b64_tr_b16 v[10:11], v42 offset:33792
  v_mfma_f32_32x32x16_bf16 v[64:79], v[32:35], v[24:27], v[64:79]
  ds_read_b64_tr_b16 v[12:13], v43 offset:32768
  ds_read_b64_tr_b16 v[14:15], v43 offset:33792
  v_mfma_f32_32x32x16_bf16 v[80:95], v[36:39], v[24:27], v[80:95]
  ds_read_b128 v[16:19], v48 offset:32768
  ds_read_b128 v[20:23], v48 offset:36864
  v_mfma_f32_32x32x16_bf16 v[96:111], v[32:35], v[28:31], v[96:111]
  v_mfma_f32_32x32x16_bf16 v[112:127], v[36:39], v[28:31], v[112:127]
  s_waitcnt lgkmcnt(0)
  ds_read_b64_tr_b16 v[24:25], v42 offset:36864
  ds_read_b64_tr_b16 v[26:27], v42 offset:37888
  v_mfma_f32_32x32x16_bf16 v[64:79], v[16:19], v[8:11], v[64:79]
  ds_read_b64_tr_b16 v[28:29], v43 offset:36864
  ds_read_b64_tr_b16 v[30:31], v43 offset:37888
  v_mfma_f32_32x32x16_bf16 v[80:95], v[20:23], v[8:11], v[80:95]
  ds_read_b128 v[32:35], v49 offset:32768
  ds_read_b128 v[36:39], v49 offset:36864
  v_mfma_f32_32x32x16_bf16 v[96:111], v[16:19], v[12:15], v[96:111]
  v_mfma_f32_32x32x16_bf16 v[112:127], v[20:23], v[12:15], v[112:127]
  s_waitcnt lgkmcnt(0)
  ds_read_b64_tr_b16 v[8:9], v42 offset:40960
  ds_read_b64_tr_b16 v[10:11], v42 offset:41984
  v_mfma_f32_32x32x16_bf16 v[64:79], v[32:35], v[24:27], v[64:79]
  ds_read_b64_tr_b16 v[12:13], v43 offset:40960
  ds_read_b64_tr_b16 v[14:15], v43 offset:41984
  v_mfma_f32_32x32x16_bf16 v[80:95], v[36:39], v[24:27], v[80:95]
  ds_read_b128 v[16:19], v50 offset:32768
  ds_read_b128 v[20:23], v50 offset:36864
  v_mfma_f32_32x32x16_bf16 v[96:111], v[32:35], v[28:31], v[96:111]
  v_mfma_f32_32x32x16_bf16 v[112:127], v[36:39], v[28:31], v[112:127]
  s_waitcnt lgkmcnt(0)
  ds_read_b64_tr_b16 v[24:25], v42 offset:45056
  ds_read_b64_tr_b16 v[26:27], v42 offset:46080
  v_mfma_f32_32x32x16_bf16 v[64:79], v[16:19], v[8:11], v[64:79]
  ds_read_b64_tr_b16 v[28:29], v43 offset:45056
  ds_read_b64_tr_b16 v[30:31], v43 offset:46080
  v_mfma_f32_32x32x16_bf16 v[80:95], v[20:23], v[8:11], v[80:95]
  ds_read_b128 v[32:35], v51 offset:32768
  ds_read_b128 v[36:39], v51 offset:36864
  v_mfma_f32_32x32x16_bf16 v[96:111], v[16:19], v[12:15], v[96:111]
  v_mfma_f32_32x32x16_bf16 v[112:127], v[20:23], v[12:15], v[112:127]
  s_waitcnt lgkmcnt(0)
  s_barrier
  ds_read_b64_tr_b16 v[8:9], v40 offset:0
  ds_read_b64_tr_b16 v[10:11], v40 offset:1024
  v_mfma_f32_32x32x16_bf16 v[64:79], v[32:35], v[24:27], v[64:79]
  ds_read_b64_tr_b16 v[12:13], v41 offset:0
  ds_read_b64_tr_b16 v[14:15], v41 offset:1024
  v_mfma_f32_32x32x16_bf16 v[80:95], v[36:39], v[24:27], v[80:95]
  ds_read_b128 v[16:19], v44 offset:0
  ds_read_b128 v[20:23], v44 offset:4096
  v_mfma_f32_32x32x16_bf16 v[96:111], v[32:35], v[28:31], v[96:111]
  v_mfma_f32_32x32x16_bf16 v[112:127], v[36:39], v[28:31], v[112:127]
  s_waitcnt lgkmcnt(0)
  ds_read_b64_tr_b16 v[24:25], v40 offset:4096
  ds_read_b64_tr_b16 v[26:27], v40 offset:5120
  v_mfma_f32_32x32x16_bf16 v[64:79], v[16:19], v[8:11], v[64:79]
  ds_read_b64_tr_b16 v[28:29], v41 offset:4096
  ds_read_b64_tr_b16 v[30:31], v41 offset:5120
  v_mfma_f32_32x32x16_bf16 v[80:95], v[20:23], v[8:11], v[80:95]
  ds_read_b128 v[32:35], v45 offset:0
  ds_read_b128 v[36:39], v45 offset:4096
  v_mfma_f32_32x32x16_bf16 v[96:111], v[16:19], v[12:15], v[96:111]
  v_mfma_f32_32x32x16_bf16 v[112:127], v[20:23], v[12:15], v[112:127]
  s_waitcnt lgkmcnt(0)
  ds_read_b64_tr_b16 v[8:9], v40 offset:8192
  ds_read_b64_tr_b16 v[10:11], v40 offset:9216
  v_mfma_f32_32x32x16_bf16 v[64:79], v[32:35], v[24:27], v[64:79]
  ds_read_b64_tr_b16 v[12:13], v41 offset:8192
  ds_read_b64_tr_b16 v[14:15], v41 offset:9216
  v_mfma_f32_32x32x16_bf16 v[80:95], v[36:39], v[24:27], v[80:95]
  ds_read_b128 v[16:19], v46 offset:0
  ds_read_b128 v[20:23], v46 offset:4096
  v_mfma_f32_32x32x16_bf16 v[96:111], v[32:35], v[28:31], v[96:111]
  v_mfma_f32_32x32x16_bf16 v[112:127], v[36:39], v[28:31], v[112:127]
  s_waitcnt lgkmcnt(0)
  ds_read_b64_tr_b16 v[24:25], v40 offset:12288
  ds_read_b64_tr_b16 v[26:27], v40 offset:13312
  v_mfma_f32_32x32x16_bf16 v[64:79], v[16:19], v[8:11], v[64:79]
  ds_read_b64_tr_b16 v[28:29], v41 offset:12288
  ds_read_b64_tr_b16 v[30:31], v41 offset:13312
  v_mfma_f32_32x32x16_bf16 v[80:95], v[20:23], v[8:11], v[80:95]
  ds_read_b128 v[32:35], v47 offset:0
  ds_read_b128 v[36:39], v47 offset:4096
  v_mfma_f32_32x32x16_bf16 v[96:111], v[16:19], v[12:15], v[96:111]
  v_mfma_f32_32x32x16_bf16 v[112:127], v[20:23], v[12:15], v[112:127]
  s_waitcnt lgkmcnt(0)
  s_barrier
  ds_read_b64_tr_b16 v[8:9], v40 offset:32768
  ds_read_b64_tr_b16 v[10:11], v40 offset:33792
  v_mfma_f32_32x32x16_bf16 v[64:79], v[32:35], v[24:27], v[64:79]
  ds_read_b64_tr_b16 v[12:13], v41 offset:32768
  ds_read_b64_tr_b16 v[14:15], v41 offset:33792
  v_mfma_f32_32x32x16_bf16 v[80:95], v[36:39], v[24:27], v[80:95]
  ds_read_b128 v[16:19], v44 offset:32768
  ds_read_b128 v[20:23], v44 offset:36864
  v_mfma_f32_32x32x16_bf16 v[96:111], v[32:35], v[28:31], v[96:111]
  v_mfma_f32_32x32x16_bf16 v[112:127], v[36:39], v[28:31], v[112:127]
  s_waitcnt lgkmcnt(0)
  ds_read_b64_tr_b16 v[24:25], v40 offset:36864
  ds_read_b64_tr_b16 v[26:27], v40 offset:37888
  v_mfma_f32_32x32x16_bf16 v[64:79], v[16:19], v[8:11], v[64:79]
  ds_read_b64_tr_b16 v[28:29], v41 offset:36864
  ds_read_b64_tr_b16 v[30:31], v41 offset:37888
  v_mfma_f32_32x32x16_bf16 v[80:95], v[20:23], v[8:11], v[80:95]
  ds_read_b128 v[32:35], v45 offset:32768
  ds_read_b128 v[36:39], v45 offset:36864
  v_mfma_f32_32x32x16_bf16 v[96:111], v[16:19], v[12:15], v[96:111]
  v_mfma_f32_32x32x16_bf16 v[112:127], v[20:23], v[12:15], v[112:127]
  s_waitcnt lgkmcnt(0)
  ds_read_b64_tr_b16 v[8:9], v40 offset:40960
  ds_read_b64_tr_b16 v[10:11], v40 offset:41984
  v_mfma_f32_32x32x16_bf16 v[64:79], v[32:35], v[24:27], v[64:79]
  ds_read_b64_tr_b16 v[12:13], v41 offset:40960
  ds_read_b64_tr_b16 v[14:15], v41 offset:41984
  v_mfma_f32_32x32x16_bf16 v[80:95], v[36:39], v[24:27], v[80:95]
  ds_read_b128 v[16:19], v46 offset:32768
  ds_read_b128 v[20:23], v46 offset:36864
  v_mfma_f32_32x32x16_bf16 v[96:111], v[32:35], v[28:31], v[96:111]
  v_mfma_f32_32x32x16_bf16 v[112:127], v[36:39], v[28:31], v[112:127]
  s_waitcnt lgkmcnt(0)
  ds_read_b64_tr_b16 v[24:25], v40 offset:45056
  ds_read_b64_tr_b16 v[26:27], v40 offset:46080
  v_mfma_f32_32x32x16_bf16 v[64:79], v[16:19], v[8:11], v[64:79]
  ds_read_b64_tr_b16 v[28:29], v41 offset:45056
  ds_read_b64_tr_b16 v[30:31], v41 offset:46080
  v_mfma_f32_32x32x16_bf16 v[80:95], v[20:23], v[8:11], v[80:95]
  ds_read_b128 v[32:35], v47 offset:32768
  ds_read_b128 v[36:39], v47 offset:36864
  v_mfma_f32_32x32x16_bf16 v[96:111], v[16:19], v[12:15], v[96:111]
  v_mfma_f32_32x32x16_bf16 v[112:127], v[20:23], v[12:15], v[112:127]
  s_waitcnt lgkmcnt(0)
  s_barrier
  ds_read_b64_tr_b16 v[8:9], v42 offset:0
  ds_read_b64_tr_b16 v[10:11], v42 offset:1024
  v_mfma_f32_32x32x16_bf16 v[64:79], v[32:35], v[24:27], v[64:79]
  ds_read_b64_tr_b16 v[12:13], v43 offset:0
  ds_read_b64_tr_b16 v[14:15], v43 offset:1024
  v_mfma_f32_32x32x16_bf16 v[80:95], v[36:39], v[24:27], v[80:95]
  ds_read_b128 v[16:19], v48 offset:0
  ds_read_b128 v[20:23], v48 offset:4096
  v_mfma_f32_32x32x16_bf16 v[96:111], v[32:35], v[28:31], v[96:111]
  v_mfma_f32_32x32x16_bf16 v[112:127], v[36:39], v[28:31], v[112:127]
  s_waitcnt lgkmcnt(0)
  ds_read_b64_tr_b16 v[24:25], v42 offset:4096
  ds_read_b64_tr_b16 v[26:27], v42 offset:5120
  v_mfma_f32_32x32x16_bf16 v[64:79], v[16:19], v[8:11], v[64:79]
  ds_read_b64_tr_b16 v[28:29], v43 offset:4096
  ds_read_b64_tr_b16 v[30:31], v43 offset:5120
  v_mfma_f32_32x32x16_bf16 v[80:95], v[20:23], v[8:11], v[80:95]
  ds_read_b128 v[32:35], v49 offset:0
  ds_read_b128 v[36:39], v49 offset:4096
  v_mfma_f32_32x32x16_bf16 v[96:111], v[16:19], v[12:15], v[96:111]
  v_mfma_f32_32x32x16_bf16 v[112:127], v[20:23], v[12:15], v[112:127]
  s_waitcnt lgkmcnt(0)
  ds_read_b64_tr_b16 v[8:9], v42 offset:8192
  ds_read_b64_tr_b16 v[10:11], v42 offset:9216
  v_mfma_f32_32x32x16_bf16 v[64:79], v[32:35], v[24:27], v[64:79]
  ds_read_b64_tr_b16 v[12:13], v43 offset:8192
  ds_read_b64_tr_b16 v[14:15], v43 offset:9216
  v_mfma_f32_32x32x16_bf16 v[80:95], v[36:39], v[24:27], v[80:95]
  ds_read_b128 v[16:19], v50 offset:0
  ds_read_b128 v[20:23], v50 offset:4096
  v_mfma_f32_32x32x16_bf16 v[96:111], v[32:35], v[28:31], v[96:111]
  v_mfma_f32_32x32x16_bf16 v[112:127], v[36:39], v[28:31], v[112:127]
  s_waitcnt lgkmcnt(0)
  ds_read_b64_tr_b16 v[24:25], v42 offset:12288
  ds_read_b64_tr_b16 v[26:27], v42 offset:13312
  v_mfma_f32_32x32x16_bf16 v[64:79], v[16:19], v[8:11], v[64:79]
  ds_read_b64_tr_b16 v[28:29], v43 offset:12288
  ds_read_b64_tr_b16 v[30:31], v43 offset:13312
  v_mfma_f32_32x32x16_bf16 v[80:95], v[20:23], v[8:11], v[80:95]
  ds_read_b128 v[32:35], v51 offset:0
  ds_read_b128 v[36:39], v51 offset:4096
  v_mfma_f32_32x32x16_bf16 v[96:111], v[16:19], v[12:15], v[96:111]
  v_mfma_f32_32x32x16_bf16 v[112:127], v[20:23], v[12:15], v[112:127]
  s_waitcnt lgkmcnt(0)
  s_barrier
  ds_read_b64_tr_b16 v[8:9], v42 offset:32768
  ds_read_b64_tr_b16 v[10:11], v42 offset:33792
  v_mfma_f32_32x32x16_bf16 v[64:79], v[32:35], v[24:27], v[64:79]
  ds_read_b64_tr_b16 v[12:13], v43 offset:32768
  ds_read_b64_tr_b16 v[14:15], v43 offset:33792
  v_mfma_f32_32x32x16_bf16 v[80:95], v[36:39], v[24:27], v[80:95]
  ds_read_b128 v[16:19], v48 offset:32768
  ds_read_b128 v[20:23], v48 offset:36864
  v_mfma_f32_32x32x16_bf16 v[96:111], v[32:35], v[28:31], v[96:111]
  v_mfma_f32_32x32x16_bf16 v[112:127], v[36:39], v[28:31], v[112:127]
  s_waitcnt lgkmcnt(0)
  ds_read_b64_tr_b16 v[24:25], v42 offset:36864
  ds_read_b64_tr_b16 v[26:27], v42 offset:37888
  v_mfma_f32_32x32x16_bf16 v[64:79], v[16:19], v[8:11], v[64:79]
  ds_read_b64_tr_b16 v[28:29], v43 offset:36864
  ds_read_b64_tr_b16 v[30:31], v43 offset:37888
  v_mfma_f32_32x32x16_bf16 v[80:95], v[20:23], v[8:11], v[80:95]
  ds_read_b128 v[32:35], v49 offset:32768
  ds_read_b128 v[36:39], v49 offset:36864
  v_mfma_f32_32x32x16_bf16 v[96:111], v[16:19], v[12:15], v[96:111]
  v_mfma_f32_32x32x16_bf16 v[112:127], v[20:23], v[12:15], v[112:127]
  s_waitcnt lgkmcnt(0)
  ds_read_b64_tr_b16 v[8:9], v42 offset:40960
  ds_read_b64_tr_b16 v[10:11], v42 offset:41984
  v_mfma_f32_32x32x16_bf16 v[64:79], v[32:35], v[24:27], v[64:79]
  ds_read_b64_tr_b16 v[12:13], v43 offset:40960
  ds_read_b64_tr_b16 v[14:15], v43 offset:41984
  v_mfma_f32_32x32x16_bf16 v[80:95], v[36:39], v[24:27], v[80:95]
  ds_read_b128 v[16:19], v50 offset:32768
  ds_read_b128 v[20:23], v50 offset:36864
  v_mfma_f32_32x32x16_bf16 v[96:111], v[32:35], v[28:31], v[96:111]
  v_mfma_f32_32x32x16_bf16 v[112:127], v[36:39], v[28:31], v[112:127]
  s_waitcnt lgkmcnt(0)
  ds_read_b64_tr_b16 v[24:25], v42 offset:45056
  ds_read_b64_tr_b16 v[26:27], v42 offset:46080
  v_mfma_f32_32x32x16_bf16 v[64:79], v[16:19], v[8:11], v[64:79]
  ds_read_b64_tr_b16 v[28:29], v43 offset:45056
  ds_read_b64_tr_b16 v[30:31], v43 offset:46080
  v_mfma_f32_32x32x16_bf16 v[80:95], v[20:23], v[8:11], v[80:95]
  ds_read_b128 v[32:35], v51 offset:32768
  ds_read_b128 v[36:39], v51 offset:36864
  v_mfma_f32_32x32x16_bf16 v[96:111], v[16:19], v[12:15], v[96:111]
  v_mfma_f32_32x32x16_bf16 v[112:127], v[20:23], v[12:15], v[112:127]
  s_waitcnt lgkmcnt(0)
  s_barrier
  ds_read_b64_tr_b16 v[8:9], v40 offset:0
  ds_read_b64_tr_b16 v[10:11], v40 offset:1024
  v_mfma_f32_32x32x16_bf16 v[64:79], v[32:35], v[24:27], v[64:79]
  ds_read_b64_tr_b16 v[12:13], v41 offset:0
  ds_read_b64_tr_b16 v[14:15], v41 offset:1024
  v_mfma_f32_32x32x16_bf16 v[80:95], v[36:39], v[24:27], v[80:95]
  ds_read_b128 v[16:19], v44 offset:0
  ds_read_b128 v[20:23], v44 offset:4096
  v_mfma_f32_32x32x16_bf16 v[96:111], v[32:35], v[28:31], v[96:111]
  v_mfma_f32_32x32x16_bf16 v[112:127], v[36:39], v[28:31], v[112:127]
  s_waitcnt lgkmcnt(0)
  ds_read_b64_tr_b16 v[24:25], v40 offset:4096
  ds_read_b64_tr_b16 v[26:27], v40 offset:5120
  v_mfma_f32_32x32x16_bf16 v[64:79], v[16:19], v[8:11], v[64:79]
  ds_read_b64_tr_b16 v[28:29], v41 offset:4096
  ds_read_b64_tr_b16 v[30:31], v41 offset:5120
  v_mfma_f32_32x32x16_bf16 v[80:95], v[20:23], v[8:11], v[80:95]
  ds_read_b128 v[32:35], v45 offset:0
  ds_read_b128 v[36:39], v45 offset:4096
  v_mfma_f32_32x32x16_bf16 v[96:111], v[16:19], v[12:15], v[96:111]
  v_mfma_f32_32x32x16_bf16 v[112:127], v[20:23], v[12:15], v[112:127]
  s_waitcnt lgkmcnt(0)
  ds_read_b64_tr_b16 v[8:9], v40 offset:8192
  ds_read_b64_tr_b16 v[10:11], v40 offset:9216
  v_mfma_f32_32x32x16_bf16 v[64:79], v[32:35], v[24:27], v[64:79]
  ds_read_b64_tr_b16 v[12:13], v41 offset:8192
  ds_read_b64_tr_b16 v[14:15], v41 offset:9216
  v_mfma_f32_32x32x16_bf16 v[80:95], v[36:39], v[24:27], v[80:95]
  ds_read_b128 v[16:19], v46 offset:0
  ds_read_b128 v[20:23], v46 offset:4096
  v_mfma_f32_32x32x16_bf16 v[96:111], v[32:35], v[28:31], v[96:111]
  v_mfma_f32_32x32x16_bf16 v[112:127], v[36:39], v[28:31], v[112:127]
  s_waitcnt lgkmcnt(0)
  ds_read_b64_tr_b16 v[24:25], v40 offset:12288
  ds_read_b64_tr_b16 v[26:27], v40 offset:13312
  v_mfma_f32_32x32x16_bf16 v[64:79], v[16:19], v[8:11], v[64:79]
  ds_read_b64_tr_b16 v[28:29], v41 offset:12288
  ds_read_b64_tr_b16 v[30:31], v41 offset:13312
  v_mfma_f32_32x32x16_bf16 v[80:95], v[20:23], v[8:11], v[80:95]
  ds_read_b128 v[32:35], v47 offset:0
  ds_read_b128 v[36:39], v47 offset:4096
  v_mfma_f32_32x32x16_bf16 v[96:111], v[16:19], v[12:15], v[96:111]
  v_mfma_f32_32x32x16_bf16 v[112:127], v[20:23], v[12:15], v[112:127]
  s_waitcnt lgkmcnt(0)
  s_barrier
  ds_read_b64_tr_b16 v[8:9], v40 offset:32768
  ds_read_b64_tr_b16 v[10:11], v40 offset:33792
  v_mfma_f32_32x32x16_bf16 v[64:79], v[32:35], v[24:27], v[64:79]
  ds_read_b64_tr_b16 v[12:13], v41 offset:32768
  ds_read_b64_tr_b16 v[14:15], v41 offset:33792
  v_mfma_f32_32x32x16_bf16 v[80:95], v[36:39], v[24:27], v[80:95]
  ds_read_b128 v[16:19], v44 offset:32768
  ds_read_b128 v[20:23], v44 offset:36864
  v_mfma_f32_32x32x16_bf16 v[96:111], v[32:35], v[28:31], v[96:111]
  v_mfma_f32_32x32x16_bf16 v[112:127], v[36:39], v[28:31], v[112:127]
  s_waitcnt lgkmcnt(0)
  ds_read_b64_tr_b16 v[24:25], v40 offset:36864
  ds_read_b64_tr_b16 v[26:27], v40 offset:37888
  v_mfma_f32_32x32x16_bf16 v[64:79], v[16:19], v[8:11], v[64:79]
  ds_read_b64_tr_b16 v[28:29], v41 offset:36864
  ds_read_b64_tr_b16 v[30:31], v41 offset:37888
  v_mfma_f32_32x32x16_bf16 v[80:95], v[20:23], v[8:11], v[80:95]
  ds_read_b128 v[32:35], v45 offset:32768
  ds_read_b128 v[36:39], v45 offset:36864
  v_mfma_f32_32x32x16_bf16 v[96:111], v[16:19], v[12:15], v[96:111]
  v_mfma_f32_32x32x16_bf16 v[112:127], v[20:23], v[12:15], v[112:127]
  s_waitcnt lgkmcnt(0)
  ds_read_b64_tr_b16 v[8:9], v40 offset:40960
  ds_read_b64_tr_b16 v[10:11], v40 offset:41984
  v_mfma_f32_32x32x16_bf16 v[64:79], v[32:35], v[24:27], v[64:79]
  ds_read_b64_tr_b16 v[12:13], v41 offset:40960
  ds_read_b64_tr_b16 v[14:15], v41 offset:41984
  v_mfma_f32_32x32x16_bf16 v[80:95], v[36:39], v[24:27], v[80:95]
  ds_read_b128 v[16:19], v46 offset:32768
  ds_read_b128 v[20:23], v46 offset:36864
  v_mfma_f32_32x32x16_bf16 v[96:111], v[32:35], v[28:31], v[96:111]
  v_mfma_f32_32x32x16_bf16 v[112:127], v[36:39], v[28:31], v[112:127]
  s_waitcnt lgkmcnt(0)
  ds_read_b64_tr_b16 v[24:25], v40 offset:45056
  ds_read_b64_tr_b16 v[26:27], v40 offset:46080
  v_mfma_f32_32x32x16_bf16 v[64:79], v[16:19], v[8:11], v[64:79]
  ds_read_b64_tr_b16 v[28:29], v41 offset:45056
  ds_read_b64_tr_b16 v[30:31], v41 offset:46080
  v_mfma_f32_32x32x16_bf16 v[80:95], v[20:23], v[8:11], v[80:95]
  ds_read_b128 v[32:35], v47 offset:32768
  ds_read_b128 v[36:39], v47 offset:36864
  v_mfma_f32_32x32x16_bf16 v[96:111], v[16:19], v[12:15], v[96:111]
  v_mfma_f32_32x32x16_bf16 v[112:127], v[20:23], v[12:15], v[112:127]
  s_waitcnt lgkmcnt(0)
  v_mfma_f32_32x32x16_bf16 v[64:79], v[32:35], v[24:27], v[64:79]
  v_mfma_f32_32x32x16_bf16 v[80:95], v[36:39], v[24:27], v[80:95]
  v_mfma_f32_32x32x16_bf16 v[96:111], v[32:35], v[28:31], v[96:111]
  v_mfma_f32_32x32x16_bf16 v[112:127], v[36:39], v[28:31], v[112:127]
  s_nop 8
  v_cvt_pk_bf16_f32 v16, v64, v65
  v_cvt_pk_bf16_f32 v17, v66, v67
  v_cvt_pk_bf16_f32 v18, v68, v69
  v_cvt_pk_bf16_f32 v19, v70, v71
  v_cvt_pk_bf16_f32 v20, v72, v73
  v_cvt_pk_bf16_f32 v21, v74, v75
  v_cvt_pk_bf16_f32 v22, v76, v77
  v_cvt_pk_bf16_f32 v23, v78, v79
  buffer_store_dwordx4 v[16:19], v56, s[32:35], s57 offen
  buffer_store_dwordx4 v[20:23], v56, s[32:35], s57 offen offset:672
  v_cvt_pk_bf16_f32 v24, v80, v81
  v_cvt_pk_bf16_f32 v25, v82, v83
  v_cvt_pk_bf16_f32 v26, v84, v85
  v_cvt_pk_bf16_f32 v27, v86, v87
  v_cvt_pk_bf16_f32 v28, v88, v89
  v_cvt_pk_bf16_f32 v29, v90, v91
  v_cvt_pk_bf16_f32 v30, v92, v93
  v_cvt_pk_bf16_f32 v31, v94, v95
  buffer_store_dwordx4 v[24:27], v56, s[32:35], s60 offen
  buffer_store_dwordx4 v[28:31], v56, s[32:35], s60 offen offset:672
  v_cvt_pk_bf16_f32 v32, v96, v97
  v_cvt_pk_bf16_f32 v33, v98, v99
  v_cvt_pk_bf16_f32 v34, v100, v101
  v_cvt_pk_bf16_f32 v35, v102, v103
  v_cvt_pk_bf16_f32 v36, v104, v105
  v_cvt_pk_bf16_f32 v37, v106, v107
  v_cvt_pk_bf16_f32 v38, v108, v109
  v_cvt_pk_bf16_f32 v39, v110, v111
  buffer_store_dwordx4 v[32:35], v57, s[32:35], s57 offen
  buffer_store_dwordx4 v[36:39], v57, s[32:35], s57 offen offset:672
  v_cvt_pk_bf16_f32 v40, v112, v113
  v_cvt_pk_bf16_f32 v41, v114, v115
  v_cvt_pk_bf16_f32 v42, v116, v117
  v_cvt_pk_bf16_f32 v43, v118, v119
  v_cvt_pk_bf16_f32 v44, v120, v121
  v_cvt_pk_bf16_f32 v45, v122, v123
  v_cvt_pk_bf16_f32 v46, v124, v125
  v_cvt_pk_bf16_f32 v47, v126, v127
  buffer_store_dwordx4 v[40:43], v57, s[32:35], s60 offen
  buffer_store_dwordx4 v[44:47], v57, s[32:35], s60 offen offset:672
  s_endpgm
proj_kernel_loader:
  s_sub_u32 s3, s3, 4
  v_mov_b32 v7, 0
  s_or_b32 s50, s2, s3
  s_cmp_lg_u32 s50, 0
  s_cbranch_scc1 proj_kernel_nononce
  s_memrealtime s[50:51]
  s_waitcnt lgkmcnt(0)
  s_or_b32 s50, s50, 1
  v_mov_b32 v2, s50
  s_mov_b32 s50, 17039360
  buffer_store_dword v2, v7, s[32:35], s50 offen
proj_kernel_nononce:
  v_subrev_u32 v13, 256, v0
  s_and_b32 s72, s2, 7
  s_lshl_b32 s72, s72, 5
  s_lshr_b32 s73, s2, 3
  s_add_u32 s72, s72, s73
  v_mov_b32 v6, 0
  s_lshl_b32 s74, s47, 7
  s_lshl_b32 s75, s46, 3
  s_add_u32 s74, s74, s75
  s_cmp_lg_u32 s46, 15
  s_cbranch_scc1 proj_kernel_loader2
  s_cmp_eq_u32 s3, 3
  s_cbranch_scc1 proj_kernel_gatesp
  v_cmp_gt_u32 vcc, 160, v13
  s_nop 0
  s_and_saveexec_b64 s[50:51], vcc
  v_lshrrev_b32 v3, 4, v13
  s_mul_i32 s54, s72, 10
  v_add_u32 v3, s54, v3
  v_lshrrev_b32 v2, 8, v3
  v_lshlrev_b32 v2, 4, v2
  v_and_b32 v4, 15, v13
  v_add_u32 v2, v2, v4
  v_lshlrev_b32 v2, 2, v2
  v_and_b32 v3, 255, v3
  v_lshlrev_b32 v3, 3, v3
  v_mul_u32_u24 v4, 1280, v3
  v_lshlrev_b32 v5, 1, v2
  v_add_u32 v4, v4, v5
  v_subrev_u32 v5, 3840, v4
  v_cmp_eq_u32 vcc, 0, v3
  v_mov_b32 v6, 0x80000000
  s_nop 0
  v_cndmask_b32 v5, v5, v6, vcc
  v_lshlrev_b32 v6, 3, v2
  s_mov_b32 s56, 5120
  buffer_load_dwordx2 v[14:15], v5, s[16:19], 0 offen offset:0
  buffer_load_dwordx2 v[16:17], v5, s[16:19], 0 offen offset:1280
  buffer_load_dwordx2 v[18:19], v5, s[16:19], 0 offen offset:2560
  buffer_load_dwordx2 v[20:21], v4, s[16:19], 0 offen offset:0
  buffer_load_dwordx2 v[22:23], v4, s[16:19], 0 offen offset:1280
  buffer_load_dwordx2 v[24:25], v4, s[16:19], 0 offen offset:2560
  buffer_load_dwordx2 v[26:27], v4, s[16:19], 0 offen offset:3840
  buffer_load_dwordx2 v[28:29], v4, s[16:19], s56 offen offset:0
  buffer_load_dwordx2 v[30:31], v4, s[16:19], s56 offen offset:1280
  buffer_load_dwordx2 v[32:33], v4, s[16:19], s56 offen offset:2560
  buffer_load_dwordx2 v[34:35], v4, s[16:19], s56 offen offset:3840
  buffer_load_dwordx2 v[36:37], v4, s[20:23], 0 offen offset:0
  buffer_load_dwordx2 v[38:39], v4, s[20:23], 0 offen offset:1280
  buffer_load_dwordx2 v[40:41], v4, s[20:23], 0 offen offset:2560
  buffer_load_dwordx2 v[42:43], v4, s[20:23], 0 offen offset:3840
  buffer_load_dwordx2 v[44:45], v4, s[20:23], s56 offen offset:0
  buffer_load_dwordx2 v[46:47], v4, s[20:23], s56 offen offset:1280
  buffer_load_dwordx2 v[48:49], v4, s[20:23], s56 offen offset:2560
  buffer_load_dwordx2 v[50:51], v4, s[20:23], s56 offen offset:3840
  buffer_load_dwordx4 v[52:55], v6, s[24:27], 0 offen
  buffer_load_dwordx4 v[56:59], v6, s[24:27], 0 offen offset:16
  v_mul_u32_u24 v7, 4352, v2
  v_lshlrev_b32 v8, 1, v3
  v_sub_u32 v7, v7, v8
  v_add_u32 v7, 8130544, v7
  s_mov_b32 s57, 0xffff0000
  s_mov_b32 s58, 4352
  s_mov_b32 s59, 8704
  s_mov_b32 s60, 13056
  s_waitcnt vmcnt(0)
  v_lshlrev_b32 v60, 16, v14
  v_lshlrev_b32 v61, 16, v16
  v_lshlrev_b32 v62, 16, v18
  v_lshlrev_b32 v63, 16, v20
  v_lshlrev_b32 v64, 16, v22
  v_lshlrev_b32 v65, 16, v24
  v_lshlrev_b32 v66, 16, v26
  v_lshlrev_b32 v67, 16, v28
  v_lshlrev_b32 v68, 16, v30
  v_lshlrev_b32 v69, 16, v32
  v_lshlrev_b32 v70, 16, v34
  v_lshlrev_b32 v72, 16, v36
  v_lshlrev_b32 v73, 16, v38
  v_lshlrev_b32 v74, 16, v40
  v_lshlrev_b32 v75, 16, v42
  v_lshlrev_b32 v76, 16, v44
  v_lshlrev_b32 v77, 16, v46
  v_lshlrev_b32 v78, 16, v48
  v_lshlrev_b32 v79, 16, v50
  v_lshlrev_b32 v80, 16, v52
  v_and_b32 v81, s57, v52
  v_lshlrev_b32 v82, 16, v53
  v_and_b32 v83, s57, v53
  v_mul_f32 v84, v60, v83
  v_fmac_f32 v84, v61, v82
  v_fmac_f32 v84, v62, v81
  v_fmac_f32 v84, v63, v80
  v_mul_f32 v84, v84, v72
  v_mul_f32 v85, v61, v83
  v_fmac_f32 v85, v62, v82
  v_fmac_f32 v85, v63, v81
  v_fmac_f32 v85, v64, v80
  v_mul_f32 v85, v85, v73
  v_mul_f32 v86, v62, v83
  v_fmac_f32 v86, v63, v82
  v_fmac_f32 v86, v64, v81
  v_fmac_f32 v86, v65, v80
  v_mul_f32 v86, v86, v74
  v_mul_f32 v87, v63, v83
  v_fmac_f32 v87, v64, v82
  v_fmac_f32 v87, v65, v81
  v_fmac_f32 v87, v66, v80
  v_mul_f32 v87, v87, v75
  v_mul_f32 v88, v64, v83
  v_fmac_f32 v88, v65, v82
  v_fmac_f32 v88, v66, v81
  v_fmac_f32 v88, v67, v80
  v_mul_f32 v88, v88, v76
  v_mul_f32 v89, v65, v83
  v_fmac_f32 v89, v66, v82
  v_fmac_f32 v89, v67, v81
  v_fmac_f32 v89, v68, v80
  v_mul_f32 v89, v89, v77
  v_mul_f32 v90, v66, v83
  v_fmac_f32 v90, v67, v82
  v_fmac_f32 v90, v68, v81
  v_fmac_f32 v90, v69, v80
  v_mul_f32 v90, v90, v78
  v_mul_f32 v91, v67, v83
  v_fmac_f32 v91, v68, v82
  v_fmac_f32 v91, v69, v81
  v_fmac_f32 v91, v70, v80
  v_mul_f32 v91, v91, v79
  v_cvt_pk_bf16_f32 v92, v91, v90
  v_cvt_pk_bf16_f32 v93, v89, v88
  v_cvt_pk_bf16_f32 v94, v87, v86
  v_cvt_pk_bf16_f32 v95, v85, v84
  buffer_store_dwordx4 v[92:95], v7, s[32:35], 0 offen
  v_and_b32 v60, s57, v14
  v_and_b32 v61, s57, v16
  v_and_b32 v62, s57, v18
  v_and_b32 v63, s57, v20
  v_and_b32 v64, s57, v22
  v_and_b32 v65, s57, v24
  v_and_b32 v66, s57, v26
  v_and_b32 v67, s57, v28
  v_and_b32 v68, s57, v30
  v_and_b32 v69, s57, v32
  v_and_b32 v70, s57, v34
  v_and_b32 v72, s57, v36
  v_and_b32 v73, s57, v38
  v_and_b32 v74, s57, v40
  v_and_b32 v75, s57, v42
  v_and_b32 v76, s57, v44
  v_and_b32 v77, s57, v46
  v_and_b32 v78, s57, v48
  v_and_b32 v79, s57, v50
  v_lshlrev_b32 v80, 16, v54
  v_and_b32 v81, s57, v54
  v_lshlrev_b32 v82, 16, v55
  v_and_b32 v83, s57, v55
  v_mul_f32 v84, v60, v83
  v_fmac_f32 v84, v61, v82
  v_fmac_f32 v84, v62, v81
  v_fmac_f32 v84, v63, v80
  v_mul_f32 v84, v84, v72
  v_mul_f32 v85, v61, v83
  v_fmac_f32 v85, v62, v82
  v_fmac_f32 v85, v63, v81
  v_fmac_f32 v85, v64, v80
  v_mul_f32 v85, v85, v73
  v_mul_f32 v86, v62, v83
  v_fmac_f32 v86, v63, v82
  v_fmac_f32 v86, v64, v81
  v_fmac_f32 v86, v65, v80
  v_mul_f32 v86, v86, v74
  v_mul_f32 v87, v63, v83
  v_fmac_f32 v87, v64, v82
  v_fmac_f32 v87, v65, v81
  v_fmac_f32 v87, v66, v80
  v_mul_f32 v87, v87, v75
  v_mul_f32 v88, v64, v83
  v_fmac_f32 v88, v65, v82
  v_fmac_f32 v88, v66, v81
  v_fmac_f32 v88, v67, v80
  v_mul_f32 v88, v88, v76
  v_mul_f32 v89, v65, v83
  v_fmac_f32 v89, v66, v82
  v_fmac_f32 v89, v67, v81
  v_fmac_f32 v89, v68, v80
  v_mul_f32 v89, v89, v77
  v_mul_f32 v90, v66, v83
  v_fmac_f32 v90, v67, v82
  v_fmac_f32 v90, v68, v81
  v_fmac_f32 v90, v69, v80
  v_mul_f32 v90, v90, v78
  v_mul_f32 v91, v67, v83
  v_fmac_f32 v91, v68, v82
  v_fmac_f32 v91, v69, v81
  v_fmac_f32 v91, v70, v80
  v_mul_f32 v91, v91, v79
  v_cvt_pk_bf16_f32 v96, v91, v90
  v_cvt_pk_bf16_f32 v97, v89, v88
  v_cvt_pk_bf16_f32 v98, v87, v86
  v_cvt_pk_bf16_f32 v99, v85, v84
  buffer_store_dwordx4 v[96:99], v7, s[32:35], s58 offen
  v_lshlrev_b32 v60, 16, v15
  v_lshlrev_b32 v61, 16, v17
  v_lshlrev_b32 v62, 16, v19
  v_lshlrev_b32 v63, 16, v21
  v_lshlrev_b32 v64, 16, v23
  v_lshlrev_b32 v65, 16, v25
  v_lshlrev_b32 v66, 16, v27
  v_lshlrev_b32 v67, 16, v29
  v_lshlrev_b32 v68, 16, v31
  v_lshlrev_b32 v69, 16, v33
  v_lshlrev_b32 v70, 16, v35
  v_lshlrev_b32 v72, 16, v37
  v_lshlrev_b32 v73, 16, v39
  v_lshlrev_b32 v74, 16, v41
  v_lshlrev_b32 v75, 16, v43
  v_lshlrev_b32 v76, 16, v45
  v_lshlrev_b32 v77, 16, v47
  v_lshlrev_b32 v78, 16, v49
  v_lshlrev_b32 v79, 16, v51
  v_lshlrev_b32 v80, 16, v56
  v_and_b32 v81, s57, v56
  v_lshlrev_b32 v82, 16, v57
  v_and_b32 v83, s57, v57
  v_mul_f32 v84, v60, v83
  v_fmac_f32 v84, v61, v82
  v_fmac_f32 v84, v62, v81
  v_fmac_f32 v84, v63, v80
  v_mul_f32 v84, v84, v72
  v_mul_f32 v85, v61, v83
  v_fmac_f32 v85, v62, v82
  v_fmac_f32 v85, v63, v81
  v_fmac_f32 v85, v64, v80
  v_mul_f32 v85, v85, v73
  v_mul_f32 v86, v62, v83
  v_fmac_f32 v86, v63, v82
  v_fmac_f32 v86, v64, v81
  v_fmac_f32 v86, v65, v80
  v_mul_f32 v86, v86, v74
  v_mul_f32 v87, v63, v83
  v_fmac_f32 v87, v64, v82
  v_fmac_f32 v87, v65, v81
  v_fmac_f32 v87, v66, v80
  v_mul_f32 v87, v87, v75
  v_mul_f32 v88, v64, v83
  v_fmac_f32 v88, v65, v82
  v_fmac_f32 v88, v66, v81
  v_fmac_f32 v88, v67, v80
  v_mul_f32 v88, v88, v76
  v_mul_f32 v89, v65, v83
  v_fmac_f32 v89, v66, v82
  v_fmac_f32 v89, v67, v81
  v_fmac_f32 v89, v68, v80
  v_mul_f32 v89, v89, v77
  v_mul_f32 v90, v66, v83
  v_fmac_f32 v90, v67, v82
  v_fmac_f32 v90, v68, v81
  v_fmac_f32 v90, v69, v80
  v_mul_f32 v90, v90, v78
  v_mul_f32 v91, v67, v83
  v_fmac_f32 v91, v68, v82
  v_fmac_f32 v91, v69, v81
  v_fmac_f32 v91, v70, v80
  v_mul_f32 v91, v91, v79
  v_cvt_pk_bf16_f32 v92, v91, v90
  v_cvt_pk_bf16_f32 v93, v89, v88
  v_cvt_pk_bf16_f32 v94, v87, v86
  v_cvt_pk_bf16_f32 v95, v85, v84
  buffer_store_dwordx4 v[92:95], v7, s[32:35], s59 offen
  v_and_b32 v60, s57, v15
  v_and_b32 v61, s57, v17
  v_and_b32 v62, s57, v19
  v_and_b32 v63, s57, v21
  v_and_b32 v64, s57, v23
  v_and_b32 v65, s57, v25
  v_and_b32 v66, s57, v27
  v_and_b32 v67, s57, v29
  v_and_b32 v68, s57, v31
  v_and_b32 v69, s57, v33
  v_and_b32 v70, s57, v35
  v_and_b32 v72, s57, v37
  v_and_b32 v73, s57, v39
  v_and_b32 v74, s57, v41
  v_and_b32 v75, s57, v43
  v_and_b32 v76, s57, v45
  v_and_b32 v77, s57, v47
  v_and_b32 v78, s57, v49
  v_and_b32 v79, s57, v51
  v_lshlrev_b32 v80, 16, v58
  v_and_b32 v81, s57, v58
  v_lshlrev_b32 v82, 16, v59
  v_and_b32 v83, s57, v59
  v_mul_f32 v84, v60, v83
  v_fmac_f32 v84, v61, v82
  v_fmac_f32 v84, v62, v81
  v_fmac_f32 v84, v63, v80
  v_mul_f32 v84, v84, v72
  v_mul_f32 v85, v61, v83
  v_fmac_f32 v85, v62, v82
  v_fmac_f32 v85, v63, v81
  v_fmac_f32 v85, v64, v80
  v_mul_f32 v85, v85, v73
  v_mul_f32 v86, v62, v83
  v_fmac_f32 v86, v63, v82
  v_fmac_f32 v86, v64, v81
  v_fmac_f32 v86, v65, v80
  v_mul_f32 v86, v86, v74
  v_mul_f32 v87, v63, v83
  v_fmac_f32 v87, v64, v82
  v_fmac_f32 v87, v65, v81
  v_fmac_f32 v87, v66, v80
  v_mul_f32 v87, v87, v75
  v_mul_f32 v88, v64, v83
  v_fmac_f32 v88, v65, v82
  v_fmac_f32 v88, v66, v81
  v_fmac_f32 v88, v67, v80
  v_mul_f32 v88, v88, v76
  v_mul_f32 v89, v65, v83
  v_fmac_f32 v89, v66, v82
  v_fmac_f32 v89, v67, v81
  v_fmac_f32 v89, v68, v80
  v_mul_f32 v89, v89, v77
  v_mul_f32 v90, v66, v83
  v_fmac_f32 v90, v67, v82
  v_fmac_f32 v90, v68, v81
  v_fmac_f32 v90, v69, v80
  v_mul_f32 v90, v90, v78
  v_mul_f32 v91, v67, v83
  v_fmac_f32 v91, v68, v82
  v_fmac_f32 v91, v69, v81
  v_fmac_f32 v91, v70, v80
  v_mul_f32 v91, v91, v79
  v_cvt_pk_bf16_f32 v96, v91, v90
  v_cvt_pk_bf16_f32 v97, v89, v88
  v_cvt_pk_bf16_f32 v98, v87, v86
  v_cvt_pk_bf16_f32 v99, v85, v84
  buffer_store_dwordx4 v[96:99], v7, s[32:35], s60 offen
  v_cmp_eq_u32 vcc, 0, v3
  s_nop 0
  s_and_saveexec_b64 s[62:63], vcc
  s_cbranch_execz proj_kernel_prep_donesp
  v_mov_b32 v100, 0
  v_mov_b32 v101, 0
  v_mov_b32 v102, 0
  v_mov_b32 v103, 0
  buffer_store_dwordx4 v[100:103], v7, s[32:35], 0 offen offset:16
  buffer_store_dwordx4 v[100:103], v7, s[32:35], s58 offen offset:16
  buffer_store_dwordx4 v[100:103], v7, s[32:35], s59 offen offset:16
  buffer_store_dwordx4 v[100:103], v7, s[32:35], s60 offen offset:16
proj_kernel_prep_donesp:
  s_mov_b64 exec, -1
  s_mov_b64 exec, -1
  s_branch proj_kernel_sidedsp
proj_kernel_gatesp:
  v_lshrrev_b32 v2, 3, v1
  v_add_u32 v2, s74, v2
  v_and_b32 v3, 7, v1
  v_mul_u32_u24 v4, 160, v3
  v_mul_u32_u24 v5, 1280, v2
  v_add_u32 v5, v5, v4
  buffer_load_dwordx4 v[14:17], v5, s[8:11], 0 offen offset:0
  buffer_load_dwordx4 v[18:21], v5, s[8:11], 0 offen offset:16
  buffer_load_dwordx4 v[22:25], v5, s[8:11], 0 offen offset:32
  buffer_load_dwordx4 v[26:29], v5, s[8:11], 0 offen offset:48
  buffer_load_dwordx4 v[30:33], v5, s[8:11], 0 offen offset:64
  buffer_load_dwordx4 v[34:37], v5, s[8:11], 0 offen offset:80
  buffer_load_dwordx4 v[38:41], v5, s[8:11], 0 offen offset:96
  buffer_load_dwordx4 v[42:45], v5, s[8:11], 0 offen offset:112
  buffer_load_dwordx4 v[46:49], v5, s[8:11], 0 offen offset:128
  buffer_load_dwordx4 v[50:53], v5, s[8:11], 0 offen offset:144
  buffer_load_dwordx4 v[54:57], v4, s[28:31], 0 offen offset:0
  buffer_load_dwordx4 v[58:61], v4, s[28:31], 0 offen offset:16
  buffer_load_dwordx4 v[62:65], v4, s[28:31], 0 offen offset:32
  buffer_load_dwordx4 v[66:69], v4, s[28:31], 0 offen offset:48
  buffer_load_dwordx4 v[70:73], v4, s[28:31], 0 offen offset:64
  buffer_load_dwordx4 v[74:77], v4, s[28:31], 0 offen offset:80
  buffer_load_dwordx4 v[78:81], v4, s[28:31], 0 offen offset:96
  buffer_load_dwordx4 v[82:85], v4, s[28:31], 0 offen offset:112
  buffer_load_dwordx4 v[86:89], v4, s[28:31], 0 offen offset:128
  buffer_load_dwordx4 v[90:93], v4, s[28:31], 0 offen offset:144
  s_mov_b32 s57, 0xffff0000
  v_mov_b32 v6, 0
  v_mov_b32 v7, 0
  s_waitcnt vmcnt(0)
  v_lshlrev_b32 v94, 16, v14
  v_lshlrev_b32 v95, 16, v54
  v_and_b32 v96, s57, v14
  v_and_b32 v97, s57, v54
  v_fmac_f32 v6, v94, v95
  v_fmac_f32 v7, v96, v97
  v_lshlrev_b32 v94, 16, v15
  v_lshlrev_b32 v95, 16, v55
  v_and_b32 v96, s57, v15
  v_and_b32 v97, s57, v55
  v_fmac_f32 v6, v94, v95
  v_fmac_f32 v7, v96, v97
  v_lshlrev_b32 v94, 16, v16
  v_lshlrev_b32 v95, 16, v56
  v_and_b32 v96, s57, v16
  v_and_b32 v97, s57, v56
  v_fmac_f32 v6, v94, v95
  v_fmac_f32 v7, v96, v97
  v_lshlrev_b32 v94, 16, v17
  v_lshlrev_b32 v95, 16, v57
  v_and_b32 v96, s57, v17
  v_and_b32 v97, s57, v57
  v_fmac_f32 v6, v94, v95
  v_fmac_f32 v7, v96, v97
  v_lshlrev_b32 v94, 16, v18
  v_lshlrev_b32 v95, 16, v58
  v_and_b32 v96, s57, v18
  v_and_b32 v97, s57, v58
  v_fmac_f32 v6, v94, v95
  v_fmac_f32 v7, v96, v97
  v_lshlrev_b32 v94, 16, v19
  v_lshlrev_b32 v95, 16, v59
  v_and_b32 v96, s57, v19
  v_and_b32 v97, s57, v59
  v_fmac_f32 v6, v94, v95
  v_fmac_f32 v7, v96, v97
  v_lshlrev_b32 v94, 16, v20
  v_lshlrev_b32 v95, 16, v60
  v_and_b32 v96, s57, v20
  v_and_b32 v97, s57, v60
  v_fmac_f32 v6, v94, v95
  v_fmac_f32 v7, v96, v97
  v_lshlrev_b32 v94, 16, v21
  v_lshlrev_b32 v95, 16, v61
  v_and_b32 v96, s57, v21
  v_and_b32 v97, s57, v61
  v_fmac_f32 v6, v94, v95
  v_fmac_f32 v7, v96, v97
  v_lshlrev_b32 v94, 16, v22
  v_lshlrev_b32 v95, 16, v62
  v_and_b32 v96, s57, v22
  v_and_b32 v97, s57, v62
  v_fmac_f32 v6, v94, v95
  v_fmac_f32 v7, v96, v97
  v_lshlrev_b32 v94, 16, v23
  v_lshlrev_b32 v95, 16, v63
  v_and_b32 v96, s57, v23
  v_and_b32 v97, s57, v63
  v_fmac_f32 v6, v94, v95
  v_fmac_f32 v7, v96, v97
  v_lshlrev_b32 v94, 16, v24
  v_lshlrev_b32 v95, 16, v64
  v_and_b32 v96, s57, v24
  v_and_b32 v97, s57, v64
  v_fmac_f32 v6, v94, v95
  v_fmac_f32 v7, v96, v97
  v_lshlrev_b32 v94, 16, v25
  v_lshlrev_b32 v95, 16, v65
  v_and_b32 v96, s57, v25
  v_and_b32 v97, s57, v65
  v_fmac_f32 v6, v94, v95
  v_fmac_f32 v7, v96, v97
  v_lshlrev_b32 v94, 16, v26
  v_lshlrev_b32 v95, 16, v66
  v_and_b32 v96, s57, v26
  v_and_b32 v97, s57, v66
  v_fmac_f32 v6, v94, v95
  v_fmac_f32 v7, v96, v97
  v_lshlrev_b32 v94, 16, v27
  v_lshlrev_b32 v95, 16, v67
  v_and_b32 v96, s57, v27
  v_and_b32 v97, s57, v67
  v_fmac_f32 v6, v94, v95
  v_fmac_f32 v7, v96, v97
  v_lshlrev_b32 v94, 16, v28
  v_lshlrev_b32 v95, 16, v68
  v_and_b32 v96, s57, v28
  v_and_b32 v97, s57, v68
  v_fmac_f32 v6, v94, v95
  v_fmac_f32 v7, v96, v97
  v_lshlrev_b32 v94, 16, v29
  v_lshlrev_b32 v95, 16, v69
  v_and_b32 v96, s57, v29
  v_and_b32 v97, s57, v69
  v_fmac_f32 v6, v94, v95
  v_fmac_f32 v7, v96, v97
  v_lshlrev_b32 v94, 16, v30
  v_lshlrev_b32 v95, 16, v70
  v_and_b32 v96, s57, v30
  v_and_b32 v97, s57, v70
  v_fmac_f32 v6, v94, v95
  v_fmac_f32 v7, v96, v97
  v_lshlrev_b32 v94, 16, v31
  v_lshlrev_b32 v95, 16, v71
  v_and_b32 v96, s57, v31
  v_and_b32 v97, s57, v71
  v_fmac_f32 v6, v94, v95
  v_fmac_f32 v7, v96, v97
  v_lshlrev_b32 v94, 16, v32
  v_lshlrev_b32 v95, 16, v72
  v_and_b32 v96, s57, v32
  v_and_b32 v97, s57, v72
  v_fmac_f32 v6, v94, v95
  v_fmac_f32 v7, v96, v97
  v_lshlrev_b32 v94, 16, v33
  v_lshlrev_b32 v95, 16, v73
  v_and_b32 v96, s57, v33
  v_and_b32 v97, s57, v73
  v_fmac_f32 v6, v94, v95
  v_fmac_f32 v7, v96, v97
  v_lshlrev_b32 v94, 16, v34
  v_lshlrev_b32 v95, 16, v74
  v_and_b32 v96, s57, v34
  v_and_b32 v97, s57, v74
  v_fmac_f32 v6, v94, v95
  v_fmac_f32 v7, v96, v97
  v_lshlrev_b32 v94, 16, v35
  v_lshlrev_b32 v95, 16, v75
  v_and_b32 v96, s57, v35
  v_and_b32 v97, s57, v75
  v_fmac_f32 v6, v94, v95
  v_fmac_f32 v7, v96, v97
  v_lshlrev_b32 v94, 16, v36
  v_lshlrev_b32 v95, 16, v76
  v_and_b32 v96, s57, v36
  v_and_b32 v97, s57, v76
  v_fmac_f32 v6, v94, v95
  v_fmac_f32 v7, v96, v97
  v_lshlrev_b32 v94, 16, v37
  v_lshlrev_b32 v95, 16, v77
  v_and_b32 v96, s57, v37
  v_and_b32 v97, s57, v77
  v_fmac_f32 v6, v94, v95
  v_fmac_f32 v7, v96, v97
  v_lshlrev_b32 v94, 16, v38
  v_lshlrev_b32 v95, 16, v78
  v_and_b32 v96, s57, v38
  v_and_b32 v97, s57, v78
  v_fmac_f32 v6, v94, v95
  v_fmac_f32 v7, v96, v97
  v_lshlrev_b32 v94, 16, v39
  v_lshlrev_b32 v95, 16, v79
  v_and_b32 v96, s57, v39
  v_and_b32 v97, s57, v79
  v_fmac_f32 v6, v94, v95
  v_fmac_f32 v7, v96, v97
  v_lshlrev_b32 v94, 16, v40
  v_lshlrev_b32 v95, 16, v80
  v_and_b32 v96, s57, v40
  v_and_b32 v97, s57, v80
  v_fmac_f32 v6, v94, v95
  v_fmac_f32 v7, v96, v97
  v_lshlrev_b32 v94, 16, v41
  v_lshlrev_b32 v95, 16, v81
  v_and_b32 v96, s57, v41
  v_and_b32 v97, s57, v81
  v_fmac_f32 v6, v94, v95
  v_fmac_f32 v7, v96, v97
  v_lshlrev_b32 v94, 16, v42
  v_lshlrev_b32 v95, 16, v82
  v_and_b32 v96, s57, v42
  v_and_b32 v97, s57, v82
  v_fmac_f32 v6, v94, v95
  v_fmac_f32 v7, v96, v97
  v_lshlrev_b32 v94, 16, v43
  v_lshlrev_b32 v95, 16, v83
  v_and_b32 v96, s57, v43
  v_and_b32 v97, s57, v83
  v_fmac_f32 v6, v94, v95
  v_fmac_f32 v7, v96, v97
  v_lshlrev_b32 v94, 16, v44
  v_lshlrev_b32 v95, 16, v84
  v_and_b32 v96, s57, v44
  v_and_b32 v97, s57, v84
  v_fmac_f32 v6, v94, v95
  v_fmac_f32 v7, v96, v97
  v_lshlrev_b32 v94, 16, v45
  v_lshlrev_b32 v95, 16, v85
  v_and_b32 v96, s57, v45
  v_and_b32 v97, s57, v85
  v_fmac_f32 v6, v94, v95
  v_fmac_f32 v7, v96, v97
  v_lshlrev_b32 v94, 16, v46
  v_lshlrev_b32 v95, 16, v86
  v_and_b32 v96, s57, v46
  v_and_b32 v97, s57, v86
  v_fmac_f32 v6, v94, v95
  v_fmac_f32 v7, v96, v97
  v_lshlrev_b32 v94, 16, v47
  v_lshlrev_b32 v95, 16, v87
  v_and_b32 v96, s57, v47
  v_and_b32 v97, s57, v87
  v_fmac_f32 v6, v94, v95
  v_fmac_f32 v7, v96, v97
  v_lshlrev_b32 v94, 16, v48
  v_lshlrev_b32 v95, 16, v88
  v_and_b32 v96, s57, v48
  v_and_b32 v97, s57, v88
  v_fmac_f32 v6, v94, v95
  v_fmac_f32 v7, v96, v97
  v_lshlrev_b32 v94, 16, v49
  v_lshlrev_b32 v95, 16, v89
  v_and_b32 v96, s57, v49
  v_and_b32 v97, s57, v89
  v_fmac_f32 v6, v94, v95
  v_fmac_f32 v7, v96, v97
  v_lshlrev_b32 v94, 16, v50
  v_lshlrev_b32 v95, 16, v90
  v_and_b32 v96, s57, v50
  v_and_b32 v97, s57, v90
  v_fmac_f32 v6, v94, v95
  v_fmac_f32 v7, v96, v97
  v_lshlrev_b32 v94, 16, v51
  v_lshlrev_b32 v95, 16, v91
  v_and_b32 v96, s57, v51
  v_and_b32 v97, s57, v91
  v_fmac_f32 v6, v94, v95
  v_fmac_f32 v7, v96, v97
  v_lshlrev_b32 v94, 16, v52
  v_lshlrev_b32 v95, 16, v92
  v_and_b32 v96, s57, v52
  v_and_b32 v97, s57, v92
  v_fmac_f32 v6, v94, v95
  v_fmac_f32 v7, v96, v97
  v_lshlrev_b32 v94, 16, v53
  v_lshlrev_b32 v95, 16, v93
  v_and_b32 v96, s57, v53
  v_and_b32 v97, s57, v93
  v_fmac_f32 v6, v94, v95
  v_fmac_f32 v7, v96, v97
  v_add_f32 v6, v6, v7
  s_nop 1
  v_add_f32_dpp v6, v6, v6 quad_perm:[1,0,3,2] row_mask:0xf bank_mask:0xf
  s_nop 1
  v_add_f32_dpp v6, v6, v6 quad_perm:[2,3,0,1] row_mask:0xf bank_mask:0xf
  s_nop 1
  v_add_f32_dpp v6, v6, v6 row_half_mirror row_mask:0xf bank_mask:0xf
  v_mul_f32 v6, 0xbfb8aa3b, v6
  v_exp_f32 v6, v6
  s_nop 0
  v_add_f32 v6, 1.0, v6
  v_rcp_f32 v6, v6
  v_lshlrev_b32 v2, 2, v2
  v_add_u32 v2, 10911744, v2
  v_cmp_eq_u32 vcc, 0, v3
  s_nop 0
  s_and_saveexec_b64 s[50:51], vcc
  buffer_store_dword v6, v2, s[32:35], 0 offen
  s_mov_b64 exec, -1
proj_kernel_sidedsp:
  s_branch proj_kernel_wopack
proj_kernel_loader2:
  v_lshrrev_b32 v2, 3, v1
  v_mul_u32_u24 v2, 1280, v2
  v_and_b32 v3, 7, v1
  v_lshrrev_b32 v4, 4, v1
  v_xor_b32 v5, v3, v4
  v_lshl_add_u32 v10, v5, 4, v2
  v_xor_b32 v5, 4, v5
  v_lshl_add_u32 v11, v5, 4, v2
  v_and_b32 v3, 15, v1
  v_lshlrev_b32 v5, 2, v4
  v_xor_b32 v3, v3, v5
  v_mul_u32_u24 v4, 3840, v4
  v_lshl_add_u32 v12, v3, 4, v4
  s_mul_i32 s52, s47, 163840
  s_mul_i32 s53, s3, 40960
  s_add_u32 s52, s52, s53
  s_lshl_b32 s53, s46, 8
  s_mul_i32 s54, s3, 61440
  s_add_u32 s53, s53, s54
  s_lshl_b32 s54, s3, 12
  s_bfe_u32 s61, s2, 0x20001
  s_mul_i32 s61, s61, 3
  s_and_b32 s60, s2, 1
  s_mul_i32 s60, s60, 5
  s_add_u32 s61, s61, s60
  s_cmp_ge_u32 s61, 10
  s_cselect_b32 s60, 10, 0
  s_sub_u32 s61, s61, s60
  s_lshl_b32 s58, s61, 7
  s_add_u32 s58, s58, s52
  s_mul_i32 s59, s61, 245760
  s_add_u32 s59, s59, s53
  s_add_u32 m0, s54, 0
  s_add_u32 s55, s58, 0
  buffer_load_dwordx4 v10, s[8:11], s55 offen lds
  s_add_u32 m0, s54, 16384
  s_add_u32 s55, s59, 0
  buffer_load_dwordx4 v12, s[12:15], s55 offen lds
  s_add_u32 m0, s54, 1024
  s_add_u32 s55, s58, 10240
  buffer_load_dwordx4 v11, s[8:11], s55 offen lds
  s_add_u32 m0, s54, 17408
  s_add_u32 s55, s59, 15360
  buffer_load_dwordx4 v12, s[12:15], s55 offen lds
  s_add_u32 m0, s54, 2048
  s_add_u32 s55, s58, 20480
  buffer_load_dwordx4 v10, s[8:11], s55 offen lds
  s_add_u32 m0, s54, 18432
  s_add_u32 s55, s59, 30720
  buffer_load_dwordx4 v12, s[12:15], s55 offen lds
  s_add_u32 m0, s54, 3072
  s_add_u32 s55, s58, 30720
  buffer_load_dwordx4 v11, s[8:11], s55 offen lds
  s_add_u32 m0, s54, 19456
  s_add_u32 s55, s59, 46080
  buffer_load_dwordx4 v12, s[12:15], s55 offen lds
  s_add_u32 s61, s61, 1
  s_cmp_eq_u32 s61, 10
  s_cselect_b32 s61, 0, s61
  s_lshl_b32 s58, s61, 7
  s_add_u32 s58, s58, s52
  s_mul_i32 s59, s61, 245760
  s_add_u32 s59, s59, s53
  s_add_u32 m0, s54, 32768
  s_add_u32 s55, s58, 0
  buffer_load_dwordx4 v10, s[8:11], s55 offen lds
  s_add_u32 m0, s54, 49152
  s_add_u32 s55, s59, 0
  buffer_load_dwordx4 v12, s[12:15], s55 offen lds
  s_add_u32 m0, s54, 33792
  s_add_u32 s55, s58, 10240
  buffer_load_dwordx4 v11, s[8:11], s55 offen lds
  s_add_u32 m0, s54, 50176
  s_add_u32 s55, s59, 15360
  buffer_load_dwordx4 v12, s[12:15], s55 offen lds
  s_add_u32 m0, s54, 34816
  s_add_u32 s55, s58, 20480
  buffer_load_dwordx4 v10, s[8:11], s55 offen lds
  s_add_u32 m0, s54, 51200
  s_add_u32 s55, s59, 30720
  buffer_load_dwordx4 v12, s[12:15], s55 offen lds
  s_add_u32 m0, s54, 35840
  s_add_u32 s55, s58, 30720
  buffer_load_dwordx4 v11, s[8:11], s55 offen lds
  s_add_u32 m0, s54, 52224
  s_add_u32 s55, s59, 46080
  buffer_load_dwordx4 v12, s[12:15], s55 offen lds
  s_add_u32 s61, s61, 1
  s_cmp_eq_u32 s61, 10
  s_cselect_b32 s61, 0, s61
  v_cmp_gt_u32 vcc, 160, v13
  s_nop 0
  s_mov_b64 s[48:49], vcc
  s_cmp_eq_u32 s3, 3
  s_cbranch_scc1 proj_kernel_tg_setup
  v_lshrrev_b32 v3, 4, v13
  s_mul_i32 s66, s72, 10
  v_add_u32 v3, s66, v3
  v_lshrrev_b32 v2, 8, v3
  v_lshlrev_b32 v2, 4, v2
  v_and_b32 v4, 15, v13
  v_add_u32 v2, v2, v4
  v_lshlrev_b32 v2, 2, v2
  v_and_b32 v3, 255, v3
  v_lshlrev_b32 v3, 3, v3
  v_mul_u32_u24 v4, 1280, v3
  v_lshlrev_b32 v5, 1, v2
  v_add_u32 v4, v4, v5
  v_subrev_u32 v5, 3840, v4
  v_cmp_eq_u32 vcc, 0, v3
  v_mov_b32 v6, 0x80000000
  s_nop 0
  v_cndmask_b32 v5, v5, v6, vcc
  v_lshlrev_b32 v6, 3, v2
  s_mov_b32 s76, 5120
  v_mul_u32_u24 v7, 4352, v2
  v_lshlrev_b32 v8, 1, v3
  v_sub_u32 v7, v7, v8
  v_add_u32 v7, 8130544, v7
  s_branch proj_kernel_t_setup_done
proj_kernel_tg_setup:
  v_lshrrev_b32 v2, 3, v1
  v_add_u32 v2, s74, v2
  v_and_b32 v3, 7, v1
  v_mul_u32_u24 v4, 160, v3
  v_mul_u32_u24 v5, 1280, v2
  v_add_u32 v5, v5, v4
proj_kernel_t_setup_done:
  s_waitcnt vmcnt(8)
  s_barrier
  s_lshl_b32 s58, s61, 7
  s_add_u32 s58, s58, s52
  s_mul_i32 s59, s61, 245760
  s_add_u32 s59, s59, s53
  s_add_u32 m0, s54, 65536
  s_add_u32 s55, s58, 0
  buffer_load_dwordx4 v10, s[8:11], s55 offen lds
  s_add_u32 m0, s54, 81920
  s_add_u32 s55, s59, 0
  buffer_load_dwordx4 v12, s[12:15], s55 offen lds
  s_add_u32 m0, s54, 66560
  s_add_u32 s55, s58, 10240
  buffer_load_dwordx4 v11, s[8:11], s55 offen lds
  s_add_u32 m0, s54, 82944
  s_add_u32 s55, s59, 15360
  buffer_load_dwordx4 v12, s[12:15], s55 offen lds
  s_add_u32 m0, s54, 67584
  s_add_u32 s55, s58, 20480
  buffer_load_dwordx4 v10, s[8:11], s55 offen lds
  s_add_u32 m0, s54, 83968
  s_add_u32 s55, s59, 30720
  buffer_load_dwordx4 v12, s[12:15], s55 offen lds
  s_add_u32 m0, s54, 68608
  s_add_u32 s55, s58, 30720
  buffer_load_dwordx4 v11, s[8:11], s55 offen lds
  s_add_u32 m0, s54, 84992
  s_add_u32 s55, s59, 46080
  buffer_load_dwordx4 v12, s[12:15], s55 offen lds
  s_add_u32 s61, s61, 1
  s_cmp_eq_u32 s61, 10
  s_cselect_b32 s61, 0, s61
  s_lshl_b32 s58, s61, 7
  s_add_u32 s58, s58, s52
  s_mul_i32 s59, s61, 245760
  s_add_u32 s59, s59, s53
  s_add_u32 m0, s54, 98304
  s_add_u32 s55, s58, 0
  buffer_load_dwordx4 v10, s[8:11], s55 offen lds
  s_add_u32 m0, s54, 114688
  s_add_u32 s55, s59, 0
  buffer_load_dwordx4 v12, s[12:15], s55 offen lds
  s_add_u32 m0, s54, 99328
  s_add_u32 s55, s58, 10240
  buffer_load_dwordx4 v11, s[8:11], s55 offen lds
  s_add_u32 m0, s54, 115712
  s_add_u32 s55, s59, 15360
  buffer_load_dwordx4 v12, s[12:15], s55 offen lds
  s_add_u32 m0, s54, 100352
  s_add_u32 s55, s58, 20480
  buffer_load_dwordx4 v10, s[8:11], s55 offen lds
  s_add_u32 m0, s54, 116736
  s_add_u32 s55, s59, 30720
  buffer_load_dwordx4 v12, s[12:15], s55 offen lds
  s_add_u32 m0, s54, 101376
  s_add_u32 s55, s58, 30720
  buffer_load_dwordx4 v11, s[8:11], s55 offen lds
  s_add_u32 m0, s54, 117760
  s_add_u32 s55, s59, 46080
  buffer_load_dwordx4 v12, s[12:15], s55 offen lds
  s_add_u32 s61, s61, 1
  s_cmp_eq_u32 s61, 10
  s_cselect_b32 s61, 0, s61
  s_waitcnt vmcnt(16)
  s_barrier
  s_lshl_b32 s58, s61, 7
  s_add_u32 s58, s58, s52
  s_mul_i32 s59, s61, 245760
  s_add_u32 s59, s59, s53
  s_add_u32 m0, s54, 0
  s_add_u32 s55, s58, 0
  buffer_load_dwordx4 v10, s[8:11], s55 offen lds
  s_add_u32 m0, s54, 16384
  s_add_u32 s55, s59, 0
  buffer_load_dwordx4 v12, s[12:15], s55 offen lds
  s_add_u32 m0, s54, 1024
  s_add_u32 s55, s58, 10240
  buffer_load_dwordx4 v11, s[8:11], s55 offen lds
  s_add_u32 m0, s54, 17408
  s_add_u32 s55, s59, 15360
  buffer_load_dwordx4 v12, s[12:15], s55 offen lds
  s_add_u32 m0, s54, 2048
  s_add_u32 s55, s58, 20480
  buffer_load_dwordx4 v10, s[8:11], s55 offen lds
  s_add_u32 m0, s54, 18432
  s_add_u32 s55, s59, 30720
  buffer_load_dwordx4 v12, s[12:15], s55 offen lds
  s_add_u32 m0, s54, 3072
  s_add_u32 s55, s58, 30720
  buffer_load_dwordx4 v11, s[8:11], s55 offen lds
  s_add_u32 m0, s54, 19456
  s_add_u32 s55, s59, 46080
  buffer_load_dwordx4 v12, s[12:15], s55 offen lds
  s_add_u32 s61, s61, 1
  s_cmp_eq_u32 s61, 10
  s_cselect_b32 s61, 0, s61
  s_waitcnt vmcnt(16)
  s_barrier
  s_lshl_b32 s58, s61, 7
  s_add_u32 s58, s58, s52
  s_mul_i32 s59, s61, 245760
  s_add_u32 s59, s59, s53
  s_add_u32 m0, s54, 32768
  s_add_u32 s55, s58, 0
  buffer_load_dwordx4 v10, s[8:11], s55 offen lds
  s_add_u32 m0, s54, 49152
  s_add_u32 s55, s59, 0
  buffer_load_dwordx4 v12, s[12:15], s55 offen lds
  s_add_u32 m0, s54, 33792
  s_add_u32 s55, s58, 10240
  buffer_load_dwordx4 v11, s[8:11], s55 offen lds
  s_add_u32 m0, s54, 50176
  s_add_u32 s55, s59, 15360
  buffer_load_dwordx4 v12, s[12:15], s55 offen lds
  s_add_u32 m0, s54, 34816
  s_add_u32 s55, s58, 20480
  buffer_load_dwordx4 v10, s[8:11], s55 offen lds
  s_add_u32 m0, s54, 51200
  s_add_u32 s55, s59, 30720
  buffer_load_dwordx4 v12, s[12:15], s55 offen lds
  s_add_u32 m0, s54, 35840
  s_add_u32 s55, s58, 30720
  buffer_load_dwordx4 v11, s[8:11], s55 offen lds
  s_add_u32 m0, s54, 52224
  s_add_u32 s55, s59, 46080
  buffer_load_dwordx4 v12, s[12:15], s55 offen lds
  s_add_u32 s61, s61, 1
  s_cmp_eq_u32 s61, 10
  s_cselect_b32 s61, 0, s61
  s_cmp_eq_u32 s3, 3
  s_cbranch_scc1 proj_kernel_tg2
  s_mov_b64 exec, s[48:49]
  buffer_load_dwordx2 v[14:15], v5, s[16:19], 0 offen offset:0
  buffer_load_dwordx2 v[16:17], v5, s[16:19], 0 offen offset:1280
  buffer_load_dwordx2 v[18:19], v5, s[16:19], 0 offen offset:2560
  s_mov_b64 exec, -1
  s_branch proj_kernel_td2
proj_kernel_tg2:
  buffer_load_dwordx4 v[14:17], v5, s[8:11], 0 offen offset:0
  buffer_load_dwordx4 v[18:21], v5, s[8:11], 0 offen offset:16
  buffer_load_dwordx4 v[22:25], v5, s[8:11], 0 offen offset:32
proj_kernel_td2:
  s_waitcnt vmcnt(19)
  s_barrier
  s_lshl_b32 s58, s61, 7
  s_add_u32 s58, s58, s52
  s_mul_i32 s59, s61, 245760
  s_add_u32 s59, s59, s53
  s_add_u32 m0, s54, 65536
  s_add_u32 s55, s58, 0
  buffer_load_dwordx4 v10, s[8:11], s55 offen lds
  s_add_u32 m0, s54, 81920
  s_add_u32 s55, s59, 0
  buffer_load_dwordx4 v12, s[12:15], s55 offen lds
  s_add_u32 m0, s54, 66560
  s_add_u32 s55, s58, 10240
  buffer_load_dwordx4 v11, s[8:11], s55 offen lds
  s_add_u32 m0, s54, 82944
  s_add_u32 s55, s59, 15360
  buffer_load_dwordx4 v12, s[12:15], s55 offen lds
  s_add_u32 m0, s54, 67584
  s_add_u32 s55, s58, 20480
  buffer_load_dwordx4 v10, s[8:11], s55 offen lds
  s_add_u32 m0, s54, 83968
  s_add_u32 s55, s59, 30720
  buffer_load_dwordx4 v12, s[12:15], s55 offen lds
  s_add_u32 m0, s54, 68608
  s_add_u32 s55, s58, 30720
  buffer_load_dwordx4 v11, s[8:11], s55 offen lds
  s_add_u32 m0, s54, 84992
  s_add_u32 s55, s59, 46080
  buffer_load_dwordx4 v12, s[12:15], s55 offen lds
  s_add_u32 s61, s61, 1
  s_cmp_eq_u32 s61, 10
  s_cselect_b32 s61, 0, s61
  s_cmp_eq_u32 s3, 3
  s_cbranch_scc1 proj_kernel_tg3
  s_mov_b64 exec, s[48:49]
  buffer_load_dwordx2 v[20:21], v4, s[16:19], 0 offen offset:0
  buffer_load_dwordx2 v[22:23], v4, s[16:19], 0 offen offset:1280
  buffer_load_dwordx2 v[24:25], v4, s[16:19], 0 offen offset:2560
  s_mov_b64 exec, -1
  s_branch proj_kernel_td3
proj_kernel_tg3:
  buffer_load_dwordx4 v[26:29], v5, s[8:11], 0 offen offset:48
  buffer_load_dwordx4 v[30:33], v5, s[8:11], 0 offen offset:64
  buffer_load_dwordx4 v[34:37], v5, s[8:11], 0 offen offset:80
proj_kernel_td3:
  s_waitcnt vmcnt(22)
  s_barrier
  s_lshl_b32 s58, s61, 7
  s_add_u32 s58, s58, s52
  s_mul_i32 s59, s61, 245760
  s_add_u32 s59, s59, s53
  s_add_u32 m0, s54, 98304
  s_add_u32 s55, s58, 0
  buffer_load_dwordx4 v10, s[8:11], s55 offen lds
  s_add_u32 m0, s54, 114688
  s_add_u32 s55, s59, 0
  buffer_load_dwordx4 v12, s[12:15], s55 offen lds
  s_add_u32 m0, s54, 99328
  s_add_u32 s55, s58, 10240
  buffer_load_dwordx4 v11, s[8:11], s55 offen lds
  s_add_u32 m0, s54, 115712
  s_add_u32 s55, s59, 15360
  buffer_load_dwordx4 v12, s[12:15], s55 offen lds
  s_add_u32 m0, s54, 100352
  s_add_u32 s55, s58, 20480
  buffer_load_dwordx4 v10, s[8:11], s55 offen lds
  s_add_u32 m0, s54, 116736
  s_add_u32 s55, s59, 30720
  buffer_load_dwordx4 v12, s[12:15], s55 offen lds
  s_add_u32 m0, s54, 101376
  s_add_u32 s55, s58, 30720
  buffer_load_dwordx4 v11, s[8:11], s55 offen lds
  s_add_u32 m0, s54, 117760
  s_add_u32 s55, s59, 46080
  buffer_load_dwordx4 v12, s[12:15], s55 offen lds
  s_add_u32 s61, s61, 1
  s_cmp_eq_u32 s61, 10
  s_cselect_b32 s61, 0, s61
  s_cmp_eq_u32 s3, 3
  s_cbranch_scc1 proj_kernel_tg4
  s_mov_b64 exec, s[48:49]
  buffer_load_dwordx2 v[26:27], v4, s[16:19], 0 offen offset:3840
  buffer_load_dwordx2 v[28:29], v4, s[16:19], s76 offen offset:0
  buffer_load_dwordx2 v[30:31], v4, s[16:19], s76 offen offset:1280
  s_mov_b64 exec, -1
  s_branch proj_kernel_td4
proj_kernel_tg4:
  buffer_load_dwordx4 v[38:41], v5, s[8:11], 0 offen offset:96
  buffer_load_dwordx4 v[42:45], v5, s[8:11], 0 offen offset:112
  buffer_load_dwordx4 v[46:49], v5, s[8:11], 0 offen offset:128
proj_kernel_td4:
  s_waitcnt vmcnt(25)
  s_barrier
  s_lshl_b32 s58, s61, 7
  s_add_u32 s58, s58, s52
  s_mul_i32 s59, s61, 245760
  s_add_u32 s59, s59, s53
  s_add_u32 m0, s54, 0
  s_add_u32 s55, s58, 0
  buffer_load_dwordx4 v10, s[8:11], s55 offen lds
  s_add_u32 m0, s54, 16384
  s_add_u32 s55, s59, 0
  buffer_load_dwordx4 v12, s[12:15], s55 offen lds
  s_add_u32 m0, s54, 1024
  s_add_u32 s55, s58, 10240
  buffer_load_dwordx4 v11, s[8:11], s55 offen lds
  s_add_u32 m0, s54, 17408
  s_add_u32 s55, s59, 15360
  buffer_load_dwordx4 v12, s[12:15], s55 offen lds
  s_add_u32 m0, s54, 2048
  s_add_u32 s55, s58, 20480
  buffer_load_dwordx4 v10, s[8:11], s55 offen lds
  s_add_u32 m0, s54, 18432
  s_add_u32 s55, s59, 30720
  buffer_load_dwordx4 v12, s[12:15], s55 offen lds
  s_add_u32 m0, s54, 3072
  s_add_u32 s55, s58, 30720
  buffer_load_dwordx4 v11, s[8:11], s55 offen lds
  s_add_u32 m0, s54, 19456
  s_add_u32 s55, s59, 46080
  buffer_load_dwordx4 v12, s[12:15], s55 offen lds
  s_add_u32 s61, s61, 1
  s_cmp_eq_u32 s61, 10
  s_cselect_b32 s61, 0, s61
  s_cmp_eq_u32 s3, 3
  s_cbranch_scc1 proj_kernel_tg5
  s_mov_b64 exec, s[48:49]
  buffer_load_dwordx2 v[32:33], v4, s[16:19], s76 offen offset:2560
  buffer_load_dwordx2 v[34:35], v4, s[16:19], s76 offen offset:3840
  buffer_load_dwordx2 v[36:37], v4, s[20:23], 0 offen offset:0
  s_mov_b64 exec, -1
  s_branch proj_kernel_td5
proj_kernel_tg5:
  buffer_load_dwordx4 v[50:53], v5, s[8:11], 0 offen offset:144
  buffer_load_dwordx4 v[54:57], v4, s[28:31], 0 offen offset:0
  buffer_load_dwordx4 v[58:61], v4, s[28:31], 0 offen offset:16
proj_kernel_td5:
  s_waitcnt vmcnt(25)
  s_barrier
  s_lshl_b32 s58, s61, 7
  s_add_u32 s58, s58, s52
  s_mul_i32 s59, s61, 245760
  s_add_u32 s59, s59, s53
  s_add_u32 m0, s54, 32768
  s_add_u32 s55, s58, 0
  buffer_load_dwordx4 v10, s[8:11], s55 offen lds
  s_add_u32 m0, s54, 49152
  s_add_u32 s55, s59, 0
  buffer_load_dwordx4 v12, s[12:15], s55 offen lds
  s_add_u32 m0, s54, 33792
  s_add_u32 s55, s58, 10240
  buffer_load_dwordx4 v11, s[8:11], s55 offen lds
  s_add_u32 m0, s54, 50176
  s_add_u32 s55, s59, 15360
  buffer_load_dwordx4 v12, s[12:15], s55 offen lds
  s_add_u32 m0, s54, 34816
  s_add_u32 s55, s58, 20480
  buffer_load_dwordx4 v10, s[8:11], s55 offen lds
  s_add_u32 m0, s54, 51200
  s_add_u32 s55, s59, 30720
  buffer_load_dwordx4 v12, s[12:15], s55 offen lds
  s_add_u32 m0, s54, 35840
  s_add_u32 s55, s58, 30720
  buffer_load_dwordx4 v11, s[8:11], s55 offen lds
  s_add_u32 m0, s54, 52224
  s_add_u32 s55, s59, 46080
  buffer_load_dwordx4 v12, s[12:15], s55 offen lds
  s_add_u32 s61, s61, 1
  s_cmp_eq_u32 s61, 10
  s_cselect_b32 s61, 0, s61
  s_cmp_eq_u32 s3, 3
  s_cbranch_scc1 proj_kernel_tg6
  s_mov_b64 exec, s[48:49]
  buffer_load_dwordx2 v[38:39], v4, s[20:23], 0 offen offset:1280
  buffer_load_dwordx2 v[40:41], v4, s[20:23], 0 offen offset:2560
  buffer_load_dwordx2 v[42:43], v4, s[20:23], 0 offen offset:3840
  buffer_load_dwordx2 v[44:45], v4, s[20:23], s76 offen offset:0
  s_mov_b64 exec, -1
  s_branch proj_kernel_td6
proj_kernel_tg6:
  buffer_load_dwordx4 v[62:65], v4, s[28:31], 0 offen offset:32
  buffer_load_dwordx4 v[66:69], v4, s[28:31], 0 offen offset:48
  buffer_load_dwordx4 v[70:73], v4, s[28:31], 0 offen offset:64
  buffer_load_dwordx4 v[74:77], v4, s[28:31], 0 offen offset:80
proj_kernel_td6:
  s_waitcnt vmcnt(26)
  s_barrier
  s_cmp_eq_u32 s3, 3
  s_cbranch_scc1 proj_kernel_tg7
  s_mov_b64 exec, s[48:49]
  buffer_load_dwordx2 v[46:47], v4, s[20:23], s76 offen offset:1280
  buffer_load_dwordx2 v[48:49], v4, s[20:23], s76 offen offset:2560
  buffer_load_dwordx2 v[50:51], v4, s[20:23], s76 offen offset:3840
  buffer_load_dwordx4 v[52:55], v6, s[24:27], 0 offen
  buffer_load_dwordx4 v[56:59], v6, s[24:27], 0 offen offset:16
  s_mov_b64 exec, -1
  s_branch proj_kernel_td7
proj_kernel_tg7:
  buffer_load_dwordx4 v[78:81], v4, s[28:31], 0 offen offset:96
  buffer_load_dwordx4 v[82:85], v4, s[28:31], 0 offen offset:112
  buffer_load_dwordx4 v[86:89], v4, s[28:31], 0 offen offset:128
  buffer_load_dwordx4 v[90:93], v4, s[28:31], 0 offen offset:144
proj_kernel_td7:
  s_waitcnt vmcnt(19)
  s_barrier
  s_waitcnt vmcnt(8)
  s_barrier
  s_cmp_eq_u32 s3, 3
  s_cbranch_scc1 proj_kernel_gateb
  v_cmp_gt_u32 vcc, 160, v13
  s_nop 0
  s_and_saveexec_b64 s[50:51], vcc
  s_mov_b32 s57, 0xffff0000
  s_mov_b32 s58, 4352
  s_mov_b32 s59, 8704
  s_mov_b32 s60, 13056
  s_waitcnt vmcnt(0)
  v_lshlrev_b32 v60, 16, v14
  v_lshlrev_b32 v61, 16, v16
  v_lshlrev_b32 v62, 16, v18
  v_lshlrev_b32 v63, 16, v20
  v_lshlrev_b32 v64, 16, v22
  v_lshlrev_b32 v65, 16, v24
  v_lshlrev_b32 v66, 16, v26
  v_lshlrev_b32 v67, 16, v28
  v_lshlrev_b32 v68, 16, v30
  v_lshlrev_b32 v69, 16, v32
  v_lshlrev_b32 v70, 16, v34
  v_lshlrev_b32 v72, 16, v36
  v_lshlrev_b32 v73, 16, v38
  v_lshlrev_b32 v74, 16, v40
  v_lshlrev_b32 v75, 16, v42
  v_lshlrev_b32 v76, 16, v44
  v_lshlrev_b32 v77, 16, v46
  v_lshlrev_b32 v78, 16, v48
  v_lshlrev_b32 v79, 16, v50
  v_lshlrev_b32 v80, 16, v52
  v_and_b32 v81, s57, v52
  v_lshlrev_b32 v82, 16, v53
  v_and_b32 v83, s57, v53
  v_mul_f32 v84, v60, v83
  v_fmac_f32 v84, v61, v82
  v_fmac_f32 v84, v62, v81
  v_fmac_f32 v84, v63, v80
  v_mul_f32 v84, v84, v72
  v_mul_f32 v85, v61, v83
  v_fmac_f32 v85, v62, v82
  v_fmac_f32 v85, v63, v81
  v_fmac_f32 v85, v64, v80
  v_mul_f32 v85, v85, v73
  v_mul_f32 v86, v62, v83
  v_fmac_f32 v86, v63, v82
  v_fmac_f32 v86, v64, v81
  v_fmac_f32 v86, v65, v80
  v_mul_f32 v86, v86, v74
  v_mul_f32 v87, v63, v83
  v_fmac_f32 v87, v64, v82
  v_fmac_f32 v87, v65, v81
  v_fmac_f32 v87, v66, v80
  v_mul_f32 v87, v87, v75
  v_mul_f32 v88, v64, v83
  v_fmac_f32 v88, v65, v82
  v_fmac_f32 v88, v66, v81
  v_fmac_f32 v88, v67, v80
  v_mul_f32 v88, v88, v76
  v_mul_f32 v89, v65, v83
  v_fmac_f32 v89, v66, v82
  v_fmac_f32 v89, v67, v81
  v_fmac_f32 v89, v68, v80
  v_mul_f32 v89, v89, v77
  v_mul_f32 v90, v66, v83
  v_fmac_f32 v90, v67, v82
  v_fmac_f32 v90, v68, v81
  v_fmac_f32 v90, v69, v80
  v_mul_f32 v90, v90, v78
  v_mul_f32 v91, v67, v83
  v_fmac_f32 v91, v68, v82
  v_fmac_f32 v91, v69, v81
  v_fmac_f32 v91, v70, v80
  v_mul_f32 v91, v91, v79
  v_cvt_pk_bf16_f32 v92, v91, v90
  v_cvt_pk_bf16_f32 v93, v89, v88
  v_cvt_pk_bf16_f32 v94, v87, v86
  v_cvt_pk_bf16_f32 v95, v85, v84
  buffer_store_dwordx4 v[92:95], v7, s[32:35], 0 offen
  v_and_b32 v60, s57, v14
  v_and_b32 v61, s57, v16
  v_and_b32 v62, s57, v18
  v_and_b32 v63, s57, v20
  v_and_b32 v64, s57, v22
  v_and_b32 v65, s57, v24
  v_and_b32 v66, s57, v26
  v_and_b32 v67, s57, v28
  v_and_b32 v68, s57, v30
  v_and_b32 v69, s57, v32
  v_and_b32 v70, s57, v34
  v_and_b32 v72, s57, v36
  v_and_b32 v73, s57, v38
  v_and_b32 v74, s57, v40
  v_and_b32 v75, s57, v42
  v_and_b32 v76, s57, v44
  v_and_b32 v77, s57, v46
  v_and_b32 v78, s57, v48
  v_and_b32 v79, s57, v50
  v_lshlrev_b32 v80, 16, v54
  v_and_b32 v81, s57, v54
  v_lshlrev_b32 v82, 16, v55
  v_and_b32 v83, s57, v55
  v_mul_f32 v84, v60, v83
  v_fmac_f32 v84, v61, v82
  v_fmac_f32 v84, v62, v81
  v_fmac_f32 v84, v63, v80
  v_mul_f32 v84, v84, v72
  v_mul_f32 v85, v61, v83
  v_fmac_f32 v85, v62, v82
  v_fmac_f32 v85, v63, v81
  v_fmac_f32 v85, v64, v80
  v_mul_f32 v85, v85, v73
  v_mul_f32 v86, v62, v83
  v_fmac_f32 v86, v63, v82
  v_fmac_f32 v86, v64, v81
  v_fmac_f32 v86, v65, v80
  v_mul_f32 v86, v86, v74
  v_mul_f32 v87, v63, v83
  v_fmac_f32 v87, v64, v82
  v_fmac_f32 v87, v65, v81
  v_fmac_f32 v87, v66, v80
  v_mul_f32 v87, v87, v75
  v_mul_f32 v88, v64, v83
  v_fmac_f32 v88, v65, v82
  v_fmac_f32 v88, v66, v81
  v_fmac_f32 v88, v67, v80
  v_mul_f32 v88, v88, v76
  v_mul_f32 v89, v65, v83
  v_fmac_f32 v89, v66, v82
  v_fmac_f32 v89, v67, v81
  v_fmac_f32 v89, v68, v80
  v_mul_f32 v89, v89, v77
  v_mul_f32 v90, v66, v83
  v_fmac_f32 v90, v67, v82
  v_fmac_f32 v90, v68, v81
  v_fmac_f32 v90, v69, v80
  v_mul_f32 v90, v90, v78
  v_mul_f32 v91, v67, v83
  v_fmac_f32 v91, v68, v82
  v_fmac_f32 v91, v69, v81
  v_fmac_f32 v91, v70, v80
  v_mul_f32 v91, v91, v79
  v_cvt_pk_bf16_f32 v96, v91, v90
  v_cvt_pk_bf16_f32 v97, v89, v88
  v_cvt_pk_bf16_f32 v98, v87, v86
  v_cvt_pk_bf16_f32 v99, v85, v84
  buffer_store_dwordx4 v[96:99], v7, s[32:35], s58 offen
  v_lshlrev_b32 v60, 16, v15
  v_lshlrev_b32 v61, 16, v17
  v_lshlrev_b32 v62, 16, v19
  v_lshlrev_b32 v63, 16, v21
  v_lshlrev_b32 v64, 16, v23
  v_lshlrev_b32 v65, 16, v25
  v_lshlrev_b32 v66, 16, v27
  v_lshlrev_b32 v67, 16, v29
  v_lshlrev_b32 v68, 16, v31
  v_lshlrev_b32 v69, 16, v33
  v_lshlrev_b32 v70, 16, v35
  v_lshlrev_b32 v72, 16, v37
  v_lshlrev_b32 v73, 16, v39
  v_lshlrev_b32 v74, 16, v41
  v_lshlrev_b32 v75, 16, v43
  v_lshlrev_b32 v76, 16, v45
  v_lshlrev_b32 v77, 16, v47
  v_lshlrev_b32 v78, 16, v49
  v_lshlrev_b32 v79, 16, v51
  v_lshlrev_b32 v80, 16, v56
  v_and_b32 v81, s57, v56
  v_lshlrev_b32 v82, 16, v57
  v_and_b32 v83, s57, v57
  v_mul_f32 v84, v60, v83
  v_fmac_f32 v84, v61, v82
  v_fmac_f32 v84, v62, v81
  v_fmac_f32 v84, v63, v80
  v_mul_f32 v84, v84, v72
  v_mul_f32 v85, v61, v83
  v_fmac_f32 v85, v62, v82
  v_fmac_f32 v85, v63, v81
  v_fmac_f32 v85, v64, v80
  v_mul_f32 v85, v85, v73
  v_mul_f32 v86, v62, v83
  v_fmac_f32 v86, v63, v82
  v_fmac_f32 v86, v64, v81
  v_fmac_f32 v86, v65, v80
  v_mul_f32 v86, v86, v74
  v_mul_f32 v87, v63, v83
  v_fmac_f32 v87, v64, v82
  v_fmac_f32 v87, v65, v81
  v_fmac_f32 v87, v66, v80
  v_mul_f32 v87, v87, v75
  v_mul_f32 v88, v64, v83
  v_fmac_f32 v88, v65, v82
  v_fmac_f32 v88, v66, v81
  v_fmac_f32 v88, v67, v80
  v_mul_f32 v88, v88, v76
  v_mul_f32 v89, v65, v83
  v_fmac_f32 v89, v66, v82
  v_fmac_f32 v89, v67, v81
  v_fmac_f32 v89, v68, v80
  v_mul_f32 v89, v89, v77
  v_mul_f32 v90, v66, v83
  v_fmac_f32 v90, v67, v82
  v_fmac_f32 v90, v68, v81
  v_fmac_f32 v90, v69, v80
  v_mul_f32 v90, v90, v78
  v_mul_f32 v91, v67, v83
  v_fmac_f32 v91, v68, v82
  v_fmac_f32 v91, v69, v81
  v_fmac_f32 v91, v70, v80
  v_mul_f32 v91, v91, v79
  v_cvt_pk_bf16_f32 v92, v91, v90
  v_cvt_pk_bf16_f32 v93, v89, v88
  v_cvt_pk_bf16_f32 v94, v87, v86
  v_cvt_pk_bf16_f32 v95, v85, v84
  buffer_store_dwordx4 v[92:95], v7, s[32:35], s59 offen
  v_and_b32 v60, s57, v15
  v_and_b32 v61, s57, v17
  v_and_b32 v62, s57, v19
  v_and_b32 v63, s57, v21
  v_and_b32 v64, s57, v23
  v_and_b32 v65, s57, v25
  v_and_b32 v66, s57, v27
  v_and_b32 v67, s57, v29
  v_and_b32 v68, s57, v31
  v_and_b32 v69, s57, v33
  v_and_b32 v70, s57, v35
  v_and_b32 v72, s57, v37
  v_and_b32 v73, s57, v39
  v_and_b32 v74, s57, v41
  v_and_b32 v75, s57, v43
  v_and_b32 v76, s57, v45
  v_and_b32 v77, s57, v47
  v_and_b32 v78, s57, v49
  v_and_b32 v79, s57, v51
  v_lshlrev_b32 v80, 16, v58
  v_and_b32 v81, s57, v58
  v_lshlrev_b32 v82, 16, v59
  v_and_b32 v83, s57, v59
  v_mul_f32 v84, v60, v83
  v_fmac_f32 v84, v61, v82
  v_fmac_f32 v84, v62, v81
  v_fmac_f32 v84, v63, v80
  v_mul_f32 v84, v84, v72
  v_mul_f32 v85, v61, v83
  v_fmac_f32 v85, v62, v82
  v_fmac_f32 v85, v63, v81
  v_fmac_f32 v85, v64, v80
  v_mul_f32 v85, v85, v73
  v_mul_f32 v86, v62, v83
  v_fmac_f32 v86, v63, v82
  v_fmac_f32 v86, v64, v81
  v_fmac_f32 v86, v65, v80
  v_mul_f32 v86, v86, v74
  v_mul_f32 v87, v63, v83
  v_fmac_f32 v87, v64, v82
  v_fmac_f32 v87, v65, v81
  v_fmac_f32 v87, v66, v80
  v_mul_f32 v87, v87, v75
  v_mul_f32 v88, v64, v83
  v_fmac_f32 v88, v65, v82
  v_fmac_f32 v88, v66, v81
  v_fmac_f32 v88, v67, v80
  v_mul_f32 v88, v88, v76
  v_mul_f32 v89, v65, v83
  v_fmac_f32 v89, v66, v82
  v_fmac_f32 v89, v67, v81
  v_fmac_f32 v89, v68, v80
  v_mul_f32 v89, v89, v77
  v_mul_f32 v90, v66, v83
  v_fmac_f32 v90, v67, v82
  v_fmac_f32 v90, v68, v81
  v_fmac_f32 v90, v69, v80
  v_mul_f32 v90, v90, v78
  v_mul_f32 v91, v67, v83
  v_fmac_f32 v91, v68, v82
  v_fmac_f32 v91, v69, v81
  v_fmac_f32 v91, v70, v80
  v_mul_f32 v91, v91, v79
  v_cvt_pk_bf16_f32 v96, v91, v90
  v_cvt_pk_bf16_f32 v97, v89, v88
  v_cvt_pk_bf16_f32 v98, v87, v86
  v_cvt_pk_bf16_f32 v99, v85, v84
  buffer_store_dwordx4 v[96:99], v7, s[32:35], s60 offen
  v_cmp_eq_u32 vcc, 0, v3
  s_nop 0
  s_and_saveexec_b64 s[62:63], vcc
  s_cbranch_execz proj_kernel_prep_doneb
  v_mov_b32 v100, 0
  v_mov_b32 v101, 0
  v_mov_b32 v102, 0
  v_mov_b32 v103, 0
  buffer_store_dwordx4 v[100:103], v7, s[32:35], 0 offen offset:16
  buffer_store_dwordx4 v[100:103], v7, s[32:35], s58 offen offset:16
  buffer_store_dwordx4 v[100:103], v7, s[32:35], s59 offen offset:16
  buffer_store_dwordx4 v[100:103], v7, s[32:35], s60 offen offset:16
proj_kernel_prep_doneb:
  s_mov_b64 exec, -1
  s_mov_b64 exec, -1
  s_branch proj_kernel_sidedb
proj_kernel_gateb:
  s_mov_b32 s57, 0xffff0000
  v_mov_b32 v6, 0
  v_mov_b32 v7, 0
  s_waitcnt vmcnt(0)
  v_lshlrev_b32 v94, 16, v14
  v_lshlrev_b32 v95, 16, v54
  v_and_b32 v96, s57, v14
  v_and_b32 v97, s57, v54
  v_fmac_f32 v6, v94, v95
  v_fmac_f32 v7, v96, v97
  v_lshlrev_b32 v94, 16, v15
  v_lshlrev_b32 v95, 16, v55
  v_and_b32 v96, s57, v15
  v_and_b32 v97, s57, v55
  v_fmac_f32 v6, v94, v95
  v_fmac_f32 v7, v96, v97
  v_lshlrev_b32 v94, 16, v16
  v_lshlrev_b32 v95, 16, v56
  v_and_b32 v96, s57, v16
  v_and_b32 v97, s57, v56
  v_fmac_f32 v6, v94, v95
  v_fmac_f32 v7, v96, v97
  v_lshlrev_b32 v94, 16, v17
  v_lshlrev_b32 v95, 16, v57
  v_and_b32 v96, s57, v17
  v_and_b32 v97, s57, v57
  v_fmac_f32 v6, v94, v95
  v_fmac_f32 v7, v96, v97
  v_lshlrev_b32 v94, 16, v18
  v_lshlrev_b32 v95, 16, v58
  v_and_b32 v96, s57, v18
  v_and_b32 v97, s57, v58
  v_fmac_f32 v6, v94, v95
  v_fmac_f32 v7, v96, v97
  v_lshlrev_b32 v94, 16, v19
  v_lshlrev_b32 v95, 16, v59
  v_and_b32 v96, s57, v19
  v_and_b32 v97, s57, v59
  v_fmac_f32 v6, v94, v95
  v_fmac_f32 v7, v96, v97
  v_lshlrev_b32 v94, 16, v20
  v_lshlrev_b32 v95, 16, v60
  v_and_b32 v96, s57, v20
  v_and_b32 v97, s57, v60
  v_fmac_f32 v6, v94, v95
  v_fmac_f32 v7, v96, v97
  v_lshlrev_b32 v94, 16, v21
  v_lshlrev_b32 v95, 16, v61
  v_and_b32 v96, s57, v21
  v_and_b32 v97, s57, v61
  v_fmac_f32 v6, v94, v95
  v_fmac_f32 v7, v96, v97
  v_lshlrev_b32 v94, 16, v22
  v_lshlrev_b32 v95, 16, v62
  v_and_b32 v96, s57, v22
  v_and_b32 v97, s57, v62
  v_fmac_f32 v6, v94, v95
  v_fmac_f32 v7, v96, v97
  v_lshlrev_b32 v94, 16, v23
  v_lshlrev_b32 v95, 16, v63
  v_and_b32 v96, s57, v23
  v_and_b32 v97, s57, v63
  v_fmac_f32 v6, v94, v95
  v_fmac_f32 v7, v96, v97
  v_lshlrev_b32 v94, 16, v24
  v_lshlrev_b32 v95, 16, v64
  v_and_b32 v96, s57, v24
  v_and_b32 v97, s57, v64
  v_fmac_f32 v6, v94, v95
  v_fmac_f32 v7, v96, v97
  v_lshlrev_b32 v94, 16, v25
  v_lshlrev_b32 v95, 16, v65
  v_and_b32 v96, s57, v25
  v_and_b32 v97, s57, v65
  v_fmac_f32 v6, v94, v95
  v_fmac_f32 v7, v96, v97
  v_lshlrev_b32 v94, 16, v26
  v_lshlrev_b32 v95, 16, v66
  v_and_b32 v96, s57, v26
  v_and_b32 v97, s57, v66
  v_fmac_f32 v6, v94, v95
  v_fmac_f32 v7, v96, v97
  v_lshlrev_b32 v94, 16, v27
  v_lshlrev_b32 v95, 16, v67
  v_and_b32 v96, s57, v27
  v_and_b32 v97, s57, v67
  v_fmac_f32 v6, v94, v95
  v_fmac_f32 v7, v96, v97
  v_lshlrev_b32 v94, 16, v28
  v_lshlrev_b32 v95, 16, v68
  v_and_b32 v96, s57, v28
  v_and_b32 v97, s57, v68
  v_fmac_f32 v6, v94, v95
  v_fmac_f32 v7, v96, v97
  v_lshlrev_b32 v94, 16, v29
  v_lshlrev_b32 v95, 16, v69
  v_and_b32 v96, s57, v29
  v_and_b32 v97, s57, v69
  v_fmac_f32 v6, v94, v95
  v_fmac_f32 v7, v96, v97
  v_lshlrev_b32 v94, 16, v30
  v_lshlrev_b32 v95, 16, v70
  v_and_b32 v96, s57, v30
  v_and_b32 v97, s57, v70
  v_fmac_f32 v6, v94, v95
  v_fmac_f32 v7, v96, v97
  v_lshlrev_b32 v94, 16, v31
  v_lshlrev_b32 v95, 16, v71
  v_and_b32 v96, s57, v31
  v_and_b32 v97, s57, v71
  v_fmac_f32 v6, v94, v95
  v_fmac_f32 v7, v96, v97
  v_lshlrev_b32 v94, 16, v32
  v_lshlrev_b32 v95, 16, v72
  v_and_b32 v96, s57, v32
  v_and_b32 v97, s57, v72
  v_fmac_f32 v6, v94, v95
  v_fmac_f32 v7, v96, v97
  v_lshlrev_b32 v94, 16, v33
  v_lshlrev_b32 v95, 16, v73
  v_and_b32 v96, s57, v33
  v_and_b32 v97, s57, v73
  v_fmac_f32 v6, v94, v95
  v_fmac_f32 v7, v96, v97
  v_lshlrev_b32 v94, 16, v34
  v_lshlrev_b32 v95, 16, v74
  v_and_b32 v96, s57, v34
  v_and_b32 v97, s57, v74
  v_fmac_f32 v6, v94, v95
  v_fmac_f32 v7, v96, v97
  v_lshlrev_b32 v94, 16, v35
  v_lshlrev_b32 v95, 16, v75
  v_and_b32 v96, s57, v35
  v_and_b32 v97, s57, v75
  v_fmac_f32 v6, v94, v95
  v_fmac_f32 v7, v96, v97
  v_lshlrev_b32 v94, 16, v36
  v_lshlrev_b32 v95, 16, v76
  v_and_b32 v96, s57, v36
  v_and_b32 v97, s57, v76
  v_fmac_f32 v6, v94, v95
  v_fmac_f32 v7, v96, v97
  v_lshlrev_b32 v94, 16, v37
  v_lshlrev_b32 v95, 16, v77
  v_and_b32 v96, s57, v37
  v_and_b32 v97, s57, v77
  v_fmac_f32 v6, v94, v95
  v_fmac_f32 v7, v96, v97
  v_lshlrev_b32 v94, 16, v38
  v_lshlrev_b32 v95, 16, v78
  v_and_b32 v96, s57, v38
  v_and_b32 v97, s57, v78
  v_fmac_f32 v6, v94, v95
  v_fmac_f32 v7, v96, v97
  v_lshlrev_b32 v94, 16, v39
  v_lshlrev_b32 v95, 16, v79
  v_and_b32 v96, s57, v39
  v_and_b32 v97, s57, v79
  v_fmac_f32 v6, v94, v95
  v_fmac_f32 v7, v96, v97
  v_lshlrev_b32 v94, 16, v40
  v_lshlrev_b32 v95, 16, v80
  v_and_b32 v96, s57, v40
  v_and_b32 v97, s57, v80
  v_fmac_f32 v6, v94, v95
  v_fmac_f32 v7, v96, v97
  v_lshlrev_b32 v94, 16, v41
  v_lshlrev_b32 v95, 16, v81
  v_and_b32 v96, s57, v41
  v_and_b32 v97, s57, v81
  v_fmac_f32 v6, v94, v95
  v_fmac_f32 v7, v96, v97
  v_lshlrev_b32 v94, 16, v42
  v_lshlrev_b32 v95, 16, v82
  v_and_b32 v96, s57, v42
  v_and_b32 v97, s57, v82
  v_fmac_f32 v6, v94, v95
  v_fmac_f32 v7, v96, v97
  v_lshlrev_b32 v94, 16, v43
  v_lshlrev_b32 v95, 16, v83
  v_and_b32 v96, s57, v43
  v_and_b32 v97, s57, v83
  v_fmac_f32 v6, v94, v95
  v_fmac_f32 v7, v96, v97
  v_lshlrev_b32 v94, 16, v44
  v_lshlrev_b32 v95, 16, v84
  v_and_b32 v96, s57, v44
  v_and_b32 v97, s57, v84
  v_fmac_f32 v6, v94, v95
  v_fmac_f32 v7, v96, v97
  v_lshlrev_b32 v94, 16, v45
  v_lshlrev_b32 v95, 16, v85
  v_and_b32 v96, s57, v45
  v_and_b32 v97, s57, v85
  v_fmac_f32 v6, v94, v95
  v_fmac_f32 v7, v96, v97
  v_lshlrev_b32 v94, 16, v46
  v_lshlrev_b32 v95, 16, v86
  v_and_b32 v96, s57, v46
  v_and_b32 v97, s57, v86
  v_fmac_f32 v6, v94, v95
  v_fmac_f32 v7, v96, v97
  v_lshlrev_b32 v94, 16, v47
  v_lshlrev_b32 v95, 16, v87
  v_and_b32 v96, s57, v47
  v_and_b32 v97, s57, v87
  v_fmac_f32 v6, v94, v95
  v_fmac_f32 v7, v96, v97
  v_lshlrev_b32 v94, 16, v48
  v_lshlrev_b32 v95, 16, v88
  v_and_b32 v96, s57, v48
  v_and_b32 v97, s57, v88
  v_fmac_f32 v6, v94, v95
  v_fmac_f32 v7, v96, v97
  v_lshlrev_b32 v94, 16, v49
  v_lshlrev_b32 v95, 16, v89
  v_and_b32 v96, s57, v49
  v_and_b32 v97, s57, v89
  v_fmac_f32 v6, v94, v95
  v_fmac_f32 v7, v96, v97
  v_lshlrev_b32 v94, 16, v50
  v_lshlrev_b32 v95, 16, v90
  v_and_b32 v96, s57, v50
  v_and_b32 v97, s57, v90
  v_fmac_f32 v6, v94, v95
  v_fmac_f32 v7, v96, v97
  v_lshlrev_b32 v94, 16, v51
  v_lshlrev_b32 v95, 16, v91
  v_and_b32 v96, s57, v51
  v_and_b32 v97, s57, v91
  v_fmac_f32 v6, v94, v95
  v_fmac_f32 v7, v96, v97
  v_lshlrev_b32 v94, 16, v52
  v_lshlrev_b32 v95, 16, v92
  v_and_b32 v96, s57, v52
  v_and_b32 v97, s57, v92
  v_fmac_f32 v6, v94, v95
  v_fmac_f32 v7, v96, v97
  v_lshlrev_b32 v94, 16, v53
  v_lshlrev_b32 v95, 16, v93
  v_and_b32 v96, s57, v53
  v_and_b32 v97, s57, v93
  v_fmac_f32 v6, v94, v95
  v_fmac_f32 v7, v96, v97
  v_add_f32 v6, v6, v7
  s_nop 1
  v_add_f32_dpp v6, v6, v6 quad_perm:[1,0,3,2] row_mask:0xf bank_mask:0xf
  s_nop 1
  v_add_f32_dpp v6, v6, v6 quad_perm:[2,3,0,1] row_mask:0xf bank_mask:0xf
  s_nop 1
  v_add_f32_dpp v6, v6, v6 row_half_mirror row_mask:0xf bank_mask:0xf
  v_mul_f32 v6, 0xbfb8aa3b, v6
  v_exp_f32 v6, v6
  s_nop 0
  v_add_f32 v6, 1.0, v6
  v_rcp_f32 v6, v6
  v_lshlrev_b32 v2, 2, v2
  v_add_u32 v2, 10911744, v2
  v_cmp_eq_u32 vcc, 0, v3
  s_nop 0
  s_and_saveexec_b64 s[50:51], vcc
  buffer_store_dword v6, v2, s[32:35], 0 offen
  s_mov_b64 exec, -1
proj_kernel_sidedb:
  s_endpgm
proj_kernel_wopack:
  s_mov_b32 s3, s77
  s_lshr_b32 s52, s47, 1
  s_and_b32 s53, s47, 1
  s_lshl_b32 s54, s47, 9
  v_add_u32 v2, s54, v0
  v_lshrrev_b32 v3, 2, v2
  v_mul_u32_u24 v3, 2688, v3
  v_and_b32 v4, 3, v2
  v_mul_u32_u24 v5, 336, v4
  v_add_u32 v5, v5, v3
  v_mov_b32 v20, 0x3f803f80
  v_mov_b32 v21, 0x3f803f80
  v_mov_b32 v22, 0x3f803f80
  v_mov_b32 v23, 0x3f803f80
  buffer_store_dwordx4 v[20:23], v5, s[32:35], 0 offen offset:1664
  v_mov_b32 v24, 0x3f80
  v_mov_b32 v25, 0
  v_cmp_eq_u32 vcc, 0, v4
  s_nop 0
  s_and_saveexec_b64 s[50:51], vcc
  buffer_store_dwordx2 v[24:25], v3, s[32:35], 0 offen offset:1280
  s_mov_b64 exec, -1
  s_lshl_b32 s54, s3, 6
  v_add_u32 v8, s54, v1
  s_mov_b32 s55, 0xcccd
  s_mul_i32 s56, s52, 160
  s_mul_i32 s57, s53, 409600
  s_add_u32 s56, s56, s57
  s_lshl_b32 s57, s3, 10
  v_add_u32 v9, 0, v8
  v_mul_u32_u24 v10, s55, v9
  v_lshrrev_b32 v10, 19, v10
  v_mul_u32_u24 v11, 1120, v10
  v_lshl_add_u32 v11, v9, 4, v11
  s_add_u32 m0, s57, 0
  s_nop 0
  buffer_load_dwordx4 v11, s[68:71], s56 offen lds
  v_add_u32 v9, 512, v8
  v_mul_u32_u24 v10, s55, v9
  v_lshrrev_b32 v10, 19, v10
  v_mul_u32_u24 v11, 1120, v10
  v_lshl_add_u32 v11, v9, 4, v11
  s_add_u32 m0, s57, 8192
  s_nop 0
  buffer_load_dwordx4 v11, s[68:71], s56 offen lds
  v_add_u32 v9, 1024, v8
  v_mul_u32_u24 v10, s55, v9
  v_lshrrev_b32 v10, 19, v10
  v_mul_u32_u24 v11, 1120, v10
  v_lshl_add_u32 v11, v9, 4, v11
  s_add_u32 m0, s57, 16384
  s_nop 0
  buffer_load_dwordx4 v11, s[68:71], s56 offen lds
  v_add_u32 v9, 1536, v8
  v_mul_u32_u24 v10, s55, v9
  v_lshrrev_b32 v10, 19, v10
  v_mul_u32_u24 v11, 1120, v10
  v_lshl_add_u32 v11, v9, 4, v11
  s_add_u32 m0, s57, 24576
  s_nop 0
  buffer_load_dwordx4 v11, s[68:71], s56 offen lds
  v_add_u32 v9, 2048, v8
  v_mul_u32_u24 v10, s55, v9
  v_lshrrev_b32 v10, 19, v10
  v_mul_u32_u24 v11, 1120, v10
  v_lshl_add_u32 v11, v9, 4, v11
  s_add_u32 m0, s57, 32768
  s_nop 0
  buffer_load_dwordx4 v11, s[68:71], s56 offen lds
  v_add_u32 v9, 2560, v8
  v_mul_u32_u24 v10, s55, v9
  v_lshrrev_b32 v10, 19, v10
  v_mul_u32_u24 v11, 1120, v10
  v_lshl_add_u32 v11, v9, 4, v11
  s_add_u32 m0, s57, 40960
  s_nop 0
  buffer_load_dwordx4 v11, s[68:71], s56 offen lds
  s_cmp_ge_u32 s3, 2
  s_cbranch_scc1 proj_kernel_wp_nodma
  v_add_u32 v9, 3072, v8
  v_mul_u32_u24 v10, s55, v9
  v_lshrrev_b32 v10, 19, v10
  v_mul_u32_u24 v11, 1120, v10
  v_lshl_add_u32 v11, v9, 4, v11
  s_add_u32 m0, s57, 49152
  s_nop 0
  buffer_load_dwordx4 v11, s[68:71], s56 offen lds
proj_kernel_wp_nodma:
  v_lshrrev_b32 v5, 4, v1
  v_bfe_u32 v6, v1, 2, 2
  v_and_b32 v14, 3, v1
  v_lshrrev_b32 v7, 1, v5
  v_mul_u32_u24 v7, 20, v7
  v_and_b32 v9, 1, v5
  v_lshl_add_u32 v7, v9, 3, v7
  v_add_u32 v7, v7, v6
  v_mul_u32_u24 v15, 160, v7
  v_lshl_add_u32 v15, v14, 3, v15
  v_mul_u32_u24 v7, 40, v5
  v_add_u32 v7, v7, v6
  v_add_u32 v7, 16, v7
  v_mul_u32_u24 v18, 160, v7
  v_lshl_add_u32 v18, v14, 3, v18
  v_lshlrev_b32 v16, 4, v1
  s_mul_i32 s56, s52, 102400
  s_add_u32 s56, s56, 16171008
  s_waitcnt vmcnt(0)
  s_barrier
  s_add_u32 s57, s3, 0
  s_mul_i32 s58, s57, 205
  s_lshr_b32 s58, s58, 10
  s_mul_i32 s59, s58, 5
  s_sub_u32 s59, s57, s59
  s_lshl_b32 s60, s59, 5
  s_cmp_ge_u32 s58, 8
  s_cbranch_scc1 proj_kernel_wp_s0
  s_mul_i32 s61, s58, 6400
  s_add_u32 s61, s61, s60
  v_add_u32 v17, s61, v15
  ds_read_b64_tr_b16 v[20:21], v17
  ds_read_b64_tr_b16 v[22:23], v17 offset:640
  s_lshl_b32 s61, s53, 3
  s_add_u32 s58, s58, s61
  s_branch proj_kernel_wp_d0
proj_kernel_wp_s0:
  s_sub_u32 s58, s58, 8
  s_mul_i32 s61, s58, 25600
  s_add_u32 s61, s61, s60
  v_add_u32 v17, s61, v18
  ds_read_b64_tr_b16 v[20:21], v17
  ds_read_b64_tr_b16 v[22:23], v17 offset:3200
  s_lshl_b32 s61, s53, 1
  s_add_u32 s58, s58, s61
  s_add_u32 s58, s58, 16
proj_kernel_wp_d0:
  s_mul_i32 s58, s58, 5
  s_add_u32 s58, s58, s59
  s_lshl_b32 s58, s58, 10
  s_add_u32 s58, s58, s56
  s_waitcnt lgkmcnt(0)
  buffer_store_dwordx4 v[20:23], v16, s[32:35], s58 offen
  s_add_u32 s57, s3, 8
  s_mul_i32 s58, s57, 205
  s_lshr_b32 s58, s58, 10
  s_mul_i32 s59, s58, 5
  s_sub_u32 s59, s57, s59
  s_lshl_b32 s60, s59, 5
  s_cmp_ge_u32 s58, 8
  s_cbranch_scc1 proj_kernel_wp_s1
  s_mul_i32 s61, s58, 6400
  s_add_u32 s61, s61, s60
  v_add_u32 v17, s61, v15
  ds_read_b64_tr_b16 v[24:25], v17
  ds_read_b64_tr_b16 v[26:27], v17 offset:640
  s_lshl_b32 s61, s53, 3
  s_add_u32 s58, s58, s61
  s_branch proj_kernel_wp_d1
proj_kernel_wp_s1:
  s_sub_u32 s58, s58, 8
  s_mul_i32 s61, s58, 25600
  s_add_u32 s61, s61, s60
  v_add_u32 v17, s61, v18
  ds_read_b64_tr_b16 v[24:25], v17
  ds_read_b64_tr_b16 v[26:27], v17 offset:3200
  s_lshl_b32 s61, s53, 1
  s_add_u32 s58, s58, s61
  s_add_u32 s58, s58, 16
proj_kernel_wp_d1:
  s_mul_i32 s58, s58, 5
  s_add_u32 s58, s58, s59
  s_lshl_b32 s58, s58, 10
  s_add_u32 s58, s58, s56
  s_waitcnt lgkmcnt(0)
  buffer_store_dwordx4 v[24:27], v16, s[32:35], s58 offen
  s_add_u32 s57, s3, 16
  s_mul_i32 s58, s57, 205
  s_lshr_b32 s58, s58, 10
  s_mul_i32 s59, s58, 5
  s_sub_u32 s59, s57, s59
  s_lshl_b32 s60, s59, 5
  s_cmp_ge_u32 s58, 8
  s_cbranch_scc1 proj_kernel_wp_s2
  s_mul_i32 s61, s58, 6400
  s_add_u32 s61, s61, s60
  v_add_u32 v17, s61, v15
  ds_read_b64_tr_b16 v[20:21], v17
  ds_read_b64_tr_b16 v[22:23], v17 offset:640
  s_lshl_b32 s61, s53, 3
  s_add_u32 s58, s58, s61
  s_branch proj_kernel_wp_d2
proj_kernel_wp_s2:
  s_sub_u32 s58, s58, 8
  s_mul_i32 s61, s58, 25600
  s_add_u32 s61, s61, s60
  v_add_u32 v17, s61, v18
  ds_read_b64_tr_b16 v[20:21], v17
  ds_read_b64_tr_b16 v[22:23], v17 offset:3200
  s_lshl_b32 s61, s53, 1
  s_add_u32 s58, s58, s61
  s_add_u32 s58, s58, 16
proj_kernel_wp_d2:
  s_mul_i32 s58, s58, 5
  s_add_u32 s58, s58, s59
  s_lshl_b32 s58, s58, 10
  s_add_u32 s58, s58, s56
  s_waitcnt lgkmcnt(0)
  buffer_store_dwordx4 v[20:23], v16, s[32:35], s58 offen
  s_add_u32 s57, s3, 24
  s_mul_i32 s58, s57, 205
  s_lshr_b32 s58, s58, 10
  s_mul_i32 s59, s58, 5
  s_sub_u32 s59, s57, s59
  s_lshl_b32 s60, s59, 5
  s_cmp_ge_u32 s58, 8
  s_cbranch_scc1 proj_kernel_wp_s3
  s_mul_i32 s61, s58, 6400
  s_add_u32 s61, s61, s60
  v_add_u32 v17, s61, v15
  ds_read_b64_tr_b16 v[24:25], v17
  ds_read_b64_tr_b16 v[26:27], v17 offset:640
  s_lshl_b32 s61, s53, 3
  s_add_u32 s58, s58, s61
  s_branch proj_kernel_wp_d3
proj_kernel_wp_s3:
  s_sub_u32 s58, s58, 8
  s_mul_i32 s61, s58, 25600
  s_add_u32 s61, s61, s60
  v_add_u32 v17, s61, v18
  ds_read_b64_tr_b16 v[24:25], v17
  ds_read_b64_tr_b16 v[26:27], v17 offset:3200
  s_lshl_b32 s61, s53, 1
  s_add_u32 s58, s58, s61
  s_add_u32 s58, s58, 16
proj_kernel_wp_d3:
  s_mul_i32 s58, s58, 5
  s_add_u32 s58, s58, s59
  s_lshl_b32 s58, s58, 10
  s_add_u32 s58, s58, s56
  s_waitcnt lgkmcnt(0)
  buffer_store_dwordx4 v[24:27], v16, s[32:35], s58 offen
  s_add_u32 s57, s3, 32
  s_mul_i32 s58, s57, 205
  s_lshr_b32 s58, s58, 10
  s_mul_i32 s59, s58, 5
  s_sub_u32 s59, s57, s59
  s_lshl_b32 s60, s59, 5
  s_cmp_ge_u32 s58, 8
  s_cbranch_scc1 proj_kernel_wp_s4
  s_mul_i32 s61, s58, 6400
  s_add_u32 s61, s61, s60
  v_add_u32 v17, s61, v15
  ds_read_b64_tr_b16 v[20:21], v17
  ds_read_b64_tr_b16 v[22:23], v17 offset:640
  s_lshl_b32 s61, s53, 3
  s_add_u32 s58, s58, s61
  s_branch proj_kernel_wp_d4
proj_kernel_wp_s4:
  s_sub_u32 s58, s58, 8
  s_mul_i32 s61, s58, 25600
  s_add_u32 s61, s61, s60
  v_add_u32 v17, s61, v18
  ds_read_b64_tr_b16 v[20:21], v17
  ds_read_b64_tr_b16 v[22:23], v17 offset:3200
  s_lshl_b32 s61, s53, 1
  s_add_u32 s58, s58, s61
  s_add_u32 s58, s58, 16
proj_kernel_wp_d4:
  s_mul_i32 s58, s58, 5
  s_add_u32 s58, s58, s59
  s_lshl_b32 s58, s58, 10
  s_add_u32 s58, s58, s56
  s_waitcnt lgkmcnt(0)
  buffer_store_dwordx4 v[20:23], v16, s[32:35], s58 offen
  s_add_u32 s57, s3, 40
  s_mul_i32 s58, s57, 205
  s_lshr_b32 s58, s58, 10
  s_mul_i32 s59, s58, 5
  s_sub_u32 s59, s57, s59
  s_lshl_b32 s60, s59, 5
  s_cmp_ge_u32 s58, 8
  s_cbranch_scc1 proj_kernel_wp_s5
  s_mul_i32 s61, s58, 6400
  s_add_u32 s61, s61, s60
  v_add_u32 v17, s61, v15
  ds_read_b64_tr_b16 v[24:25], v17
  ds_read_b64_tr_b16 v[26:27], v17 offset:640
  s_lshl_b32 s61, s53, 3
  s_add_u32 s58, s58, s61
  s_branch proj_kernel_wp_d5
proj_kernel_wp_s5:
  s_sub_u32 s58, s58, 8
  s_mul_i32 s61, s58, 25600
  s_add_u32 s61, s61, s60
  v_add_u32 v17, s61, v18
  ds_read_b64_tr_b16 v[24:25], v17
  ds_read_b64_tr_b16 v[26:27], v17 offset:3200
  s_lshl_b32 s61, s53, 1
  s_add_u32 s58, s58, s61
  s_add_u32 s58, s58, 16
proj_kernel_wp_d5:
  s_mul_i32 s58, s58, 5
  s_add_u32 s58, s58, s59
  s_lshl_b32 s58, s58, 10
  s_add_u32 s58, s58, s56
  s_waitcnt lgkmcnt(0)
  buffer_store_dwordx4 v[24:27], v16, s[32:35], s58 offen
  s_cmp_ge_u32 s3, 2
  s_cbranch_scc1 proj_kernel_end
  s_add_u32 s57, s3, 48
  s_mul_i32 s58, s57, 205
  s_lshr_b32 s58, s58, 10
  s_mul_i32 s59, s58, 5
  s_sub_u32 s59, s57, s59
  s_lshl_b32 s60, s59, 5
  s_cmp_ge_u32 s58, 8
  s_cbranch_scc1 proj_kernel_wp_s6
  s_mul_i32 s61, s58, 6400
  s_add_u32 s61, s61, s60
  v_add_u32 v17, s61, v15
  ds_read_b64_tr_b16 v[20:21], v17
  ds_read_b64_tr_b16 v[22:23], v17 offset:640
  s_lshl_b32 s61, s53, 3
  s_add_u32 s58, s58, s61
  s_branch proj_kernel_wp_d6
proj_kernel_wp_s6:
  s_sub_u32 s58, s58, 8
  s_mul_i32 s61, s58, 25600
  s_add_u32 s61, s61, s60
  v_add_u32 v17, s61, v18
  ds_read_b64_tr_b16 v[20:21], v17
  ds_read_b64_tr_b16 v[22:23], v17 offset:3200
  s_lshl_b32 s61, s53, 1
  s_add_u32 s58, s58, s61
  s_add_u32 s58, s58, 16
proj_kernel_wp_d6:
  s_mul_i32 s58, s58, 5
  s_add_u32 s58, s58, s59
  s_lshl_b32 s58, s58, 10
  s_add_u32 s58, s58, s56
  s_waitcnt lgkmcnt(0)
  buffer_store_dwordx4 v[20:23], v16, s[32:35], s58 offen
proj_kernel_end:
  s_endpgm

.globl attn_kernel
.p2align 8
.type attn_kernel,@function
attn_kernel:
  s_cmp_ge_u32 s2, 256
  s_cbranch_scc1 attn_kernel_end
  s_load_dwordx2 s[4:5], s[0:1], 96
  s_load_dwordx4 s[36:39], s[0:1], 56
  s_load_dwordx4 s[40:43], s[0:1], 80
  s_load_dwordx2 s[44:45], s[0:1], 0
  s_load_dwordx4 s[60:63], s[0:1], 32
  s_load_dwordx2 s[6:7], s[0:1], 48
  s_load_dwordx2 s[56:57], s[0:1], 72
  v_lshrrev_b32 v2, 6, v0
  v_and_b32 v1, 63, v0
  v_readfirstlane_b32 s3, v2
  s_and_b32 s46, s2, 7
  s_lshr_b32 s47, s2, 3
  s_and_b32 s48, s47, 3
  s_lshl_b32 s46, s46, 2
  s_add_u32 s46, s46, s48
  s_lshr_b32 s47, s47, 2
  s_waitcnt lgkmcnt(0)
  s_mov_b32 s8, s4
  s_and_b32 s9, s5, 0xffff
  s_mov_b32 s10, 17055744
  s_mov_b32 s11, 0x00020000
  s_add_u32 s32, s4, 17039360
  s_addc_u32 s33, s5, 0
  s_load_dword s34, s[32:33], 0
  s_mov_b32 s77, s3
  s_cmp_ge_u32 s3, 8
  s_cbranch_scc1 attn_kernel_aux
  s_lshr_b32 s48, s3, 1
  s_and_b32 s49, s3, 1
  v_lshlrev_b32 v56, 4, v1
  s_lshl_b32 s56, s46, 6
  s_lshl_b32 s57, s47, 3
  s_add_u32 s56, s56, s57
  s_lshl_b32 s57, s48, 1
  s_add_u32 s56, s56, s57
  s_mul_i32 s56, s56, 1280
  s_add_u32 s56, s56, 5505024
  v_and_b32 v59, 31, v1
  v_lshlrev_b32 v59, 3, v59
  s_mov_b32 s50, -1
  s_mov_b32 s51, 0
  s_mov_b32 s54, 0
  s_mov_b32 s55, -1
  v_mov_b32 v10, 0
  v_mov_b32 v11, 0
  v_mov_b32 v12, 0
  v_mov_b32 v13, 0
  buffer_load_dwordx4 v[2:5], v56, s[8:11], s56 offen offset:0
  buffer_load_dwordx4 v[6:9], v56, s[8:11], s56 offen offset:1280
  s_mov_b64 exec, s[50:51]
  buffer_load_dwordx2 v[10:11], v59, s[8:11], s56 offen offset:1024
  buffer_load_dwordx2 v[12:13], v59, s[8:11], s56 offen offset:2304
  s_mov_b64 exec, -1
  v_mov_b32 v57, 161792
  s_mul_i32 s57, s49, 10752
  v_add_u32 v53, s57, v56
  v_add_u32 v59, 1024, v59
  v_mov_b32 v60, 1280
  v_cmp_gt_u32 vcc, 32, v1
  s_nop 1
  v_cndmask_b32 v59, v60, v59, vcc
  v_add_u32 v54, s57, v59
  v_lshrrev_b32 v60, 5, v1
  v_mul_u32_u24 v60, 336, v60
  v_and_b32 v61, 31, v1
  v_min_u32 v61, 20, v61
  v_lshl_add_u32 v60, v61, 4, v60
  v_add_u32 v60, 1344, v60
  v_add_u32 v55, s57, v60
  v_mov_b32 v50, v53
  v_mov_b32 v51, v54
  v_mov_b32 v52, v55
  v_and_b32 v161, 31, v1
  v_lshrrev_b32 v160, 3, v161
  v_lshlrev_b32 v160, 16, v160
  v_and_b32 v62, 1, v161
  v_lshlrev_b32 v62, 2, v62
  v_bfe_u32 v63, v161, 1, 2
  v_add_u32 v62, v62, v63
  v_lshl_add_u32 v160, v62, 4, v160
  v_lshrrev_b32 v62, 5, v1
  v_lshl_add_u32 v160, v62, 8, v160
  v_lshlrev_b32 v161, 3, v161
  s_lshl_b32 s66, s47, 18
  s_lshl_b32 s63, s48, 14
  s_add_u32 s66, s66, s63
  s_lshl_b32 s63, s49, 7
  s_add_u32 s66, s66, s63
  s_lshl_b32 s63, s46, 9
  s_add_u32 s66, s66, s63
  s_add_u32 s66, s66, 10928128
  s_lshl_b32 s67, s46, 6
  s_lshl_b32 s63, s47, 3
  s_add_u32 s67, s67, s63
  s_add_u32 s67, s67, s3
  s_lshl_b32 s67, s67, 8
  s_add_u32 s67, s67, 13025280
  s_and_b32 s63, s3, 3
  s_mul_i32 s64, s63, 3072
  s_xor_b32 s63, s63, 1
  s_mul_i32 s65, s63, 3072
  s_cmp_ge_u32 s3, 4
  s_cselect_b32 s63, 43008, 0
  s_add_u32 s64, s64, s63
  s_add_u32 s65, s65, s63
  v_mov_b32 v64, 0
  v_mov_b32 v65, 0
  v_mov_b32 v66, 0
  v_mov_b32 v67, 0
  v_mov_b32 v68, 0
  v_mov_b32 v69, 0
  v_mov_b32 v70, 0
  v_mov_b32 v71, 0
  v_mov_b32 v72, 0
  v_mov_b32 v73, 0
  v_mov_b32 v74, 0
  v_mov_b32 v75, 0
  v_mov_b32 v76, 0
  v_mov_b32 v77, 0
  v_mov_b32 v78, 0
  v_mov_b32 v79, 0
  v_mov_b32 v80, 0
  v_mov_b32 v81, 0
  v_mov_b32 v82, 0
  v_mov_b32 v83, 0
  v_mov_b32 v84, 0
  v_mov_b32 v85, 0
  v_mov_b32 v86, 0
  v_mov_b32 v87, 0
  v_mov_b32 v88, 0
  v_mov_b32 v89, 0
  v_mov_b32 v90, 0
  v_mov_b32 v91, 0
  v_mov_b32 v92, 0
  v_mov_b32 v93, 0
  v_mov_b32 v94, 0
  v_mov_b32 v95, 0
  v_mov_b32 v42, 0
  v_mov_b32 v43, 0
  v_mov_b32 v44, 0
  v_mov_b32 v45, 0
  v_mov_b32 v46, 0
  v_mov_b32 v47, 0
  v_mov_b32 v48, 0
  v_mov_b32 v49, 0
  v_mov_b32 v156, 0
  v_mov_b32 v157, 0
  v_mov_b32 v158, 0
  v_mov_b32 v159, 0
  v_mov_b32 v30, 0
  v_mov_b32 v31, 0
  v_mov_b32 v32, 0
  v_mov_b32 v33, 0
  v_mov_b32 v162, 1
  s_setprio 1
  s_waitcnt lgkmcnt(0)
  s_barrier
  ds_read_b128 v[18:21], v56 offset:0
  ds_read_b64 v[24:25], v59
  ds_read_b128 v[14:17], v50 offset:0
  ds_read_b64 v[22:23], v51 offset:0
  s_waitcnt vmcnt(0) lgkmcnt(2)
  v_mfma_f32_32x32x16_bf16 v[96:111], v[18:21], v[2:5], 0
  v_mfma_f32_32x32x8_bf16 v[96:111], v[24:25], v[10:11], v[96:111]
  v_mfma_f32_32x32x16_bf16 v[112:127], v[18:21], v[6:9], 0
  v_mfma_f32_32x32x8_bf16 v[112:127], v[24:25], v[12:13], v[112:127]
  ds_read_b128 v[18:21], v50 offset:2688
  ds_read_b64 v[24:25], v51 offset:2688
  ds_read_b128 v[26:29], v52 offset:0
  s_nop 6
  v_max3_f32 v58, v96, v97, v98
  v_max3_f32 v58, v58, v99, v100
  v_max3_f32 v58, v58, v101, v102
  v_max3_f32 v58, v58, v103, v104
  v_max3_f32 v58, v58, v105, v106
  v_max3_f32 v58, v58, v107, v108
  v_max3_f32 v58, v58, v109, v110
  v_max_f32 v58, v58, v111
  v_mov_b32 v59, v58
  s_nop 1
  v_permlane32_swap_b32 v58, v59
  v_max_f32 v58, v58, v59
  v_sub_f32 v58, 0, v58
  v_cvt_pk_bf16_f32 v58, v58, 0
  s_mov_b64 exec, s[54:55]
  v_mov_b32 v10, v58
  s_mov_b64 exec, -1
  v_max3_f32 v58, v112, v113, v114
  v_max3_f32 v58, v58, v115, v116
  v_max3_f32 v58, v58, v117, v118
  v_max3_f32 v58, v58, v119, v120
  v_max3_f32 v58, v58, v121, v122
  v_max3_f32 v58, v58, v123, v124
  v_max3_f32 v58, v58, v125, v126
  v_max_f32 v58, v58, v127
  v_mov_b32 v59, v58
  s_nop 1
  v_permlane32_swap_b32 v58, v59
  v_max_f32 v58, v58, v59
  v_sub_f32 v58, 0, v58
  v_cvt_pk_bf16_f32 v58, v58, 0
  s_mov_b64 exec, s[54:55]
  v_mov_b32 v12, v58
  s_mov_b64 exec, -1
  s_waitcnt lgkmcnt(3)
  v_mfma_f32_32x32x16_bf16 v[96:111], v[14:17], v[2:5], 0
  v_mfma_f32_32x32x8_bf16 v[96:111], v[22:23], v[10:11], v[96:111]
  v_mfma_f32_32x32x16_bf16 v[112:127], v[14:17], v[6:9], 0
  v_mfma_f32_32x32x8_bf16 v[112:127], v[22:23], v[12:13], v[112:127]
  s_mov_b32 s58, 0
  s_mov_b32 s59, 0
attn_kernel_loop:
  s_add_u32 s60, s59, 21504
  s_cmp_eq_u32 s60, 64512
  s_cselect_b32 s60, 0, s60
  s_setprio 2
  s_waitcnt lgkmcnt(1)
  v_mfma_f32_32x32x16_bf16 v[128:143], v[18:21], v[2:5], 0
  v_cvt_pk_bf16_f32 v48, v156, v157
  v_cvt_pk_bf16_f32 v49, v158, v159
  v_exp_f32 v96, v96
  v_exp_f32 v97, v97
  v_exp_f32 v98, v98
  v_exp_f32 v99, v99
  s_setprio 1
  v_mfma_f32_32x32x16_bf16 v[80:95], v[30:33], v[46:49], v[80:95]
  ds_read_b128 v[30:33], v52 offset:672
  v_cvt_pk_bf16_f32 v34, v96, v97
  v_cvt_pk_bf16_f32 v35, v98, v99
  v_exp_f32 v100, v100
  v_exp_f32 v101, v101
  v_exp_f32 v102, v102
  v_exp_f32 v103, v103
  s_setprio 2
  v_mfma_f32_32x32x8_bf16 v[128:143], v[24:25], v[10:11], v[128:143]
  ds_read_b128 v[14:17], v50 offset:5376
  ds_read_b64 v[22:23], v51 offset:5376
  v_cvt_pk_bf16_f32 v36, v100, v101
  v_cvt_pk_bf16_f32 v37, v102, v103
  v_exp_f32 v104, v104
  v_exp_f32 v105, v105
  v_exp_f32 v106, v106
  v_exp_f32 v107, v107
  s_setprio 1
  s_waitcnt lgkmcnt(3)
  v_mfma_f32_32x32x16_bf16 v[64:79], v[26:29], v[34:37], v[64:79]
  v_cvt_pk_bf16_f32 v38, v104, v105
  v_cvt_pk_bf16_f32 v39, v106, v107
  v_exp_f32 v108, v108
  v_exp_f32 v109, v109
  v_exp_f32 v110, v110
  v_exp_f32 v111, v111
  s_setprio 2
  v_mfma_f32_32x32x16_bf16 v[144:159], v[18:21], v[6:9], 0
  v_cvt_pk_bf16_f32 v40, v108, v109
  v_cvt_pk_bf16_f32 v41, v110, v111
  v_exp_f32 v112, v112
  v_exp_f32 v113, v113
  v_exp_f32 v114, v114
  v_exp_f32 v115, v115
  s_setprio 1
  s_waitcnt lgkmcnt(2)
  v_mfma_f32_32x32x16_bf16 v[64:79], v[30:33], v[38:41], v[64:79]
  v_cvt_pk_bf16_f32 v42, v112, v113
  v_cvt_pk_bf16_f32 v43, v114, v115
  v_exp_f32 v116, v116
  v_exp_f32 v117, v117
  v_exp_f32 v118, v118
  v_exp_f32 v119, v119
  s_setprio 2
  v_mfma_f32_32x32x8_bf16 v[144:159], v[24:25], v[12:13], v[144:159]
  v_cvt_pk_bf16_f32 v44, v116, v117
  v_cvt_pk_bf16_f32 v45, v118, v119
  v_exp_f32 v120, v120
  v_exp_f32 v121, v121
  v_exp_f32 v122, v122
  v_exp_f32 v123, v123
  s_setprio 1
  v_mfma_f32_32x32x16_bf16 v[80:95], v[26:29], v[42:45], v[80:95]
  ds_read_b128 v[26:29], v52 offset:2688
  v_cvt_pk_bf16_f32 v46, v120, v121
  v_cvt_pk_bf16_f32 v47, v122, v123
  v_exp_f32 v124, v124
  v_exp_f32 v125, v125
  v_exp_f32 v126, v126
  v_exp_f32 v127, v127
  s_setprio 2
  s_waitcnt lgkmcnt(1)
  v_mfma_f32_32x32x16_bf16 v[96:111], v[14:17], v[2:5], 0
  v_cvt_pk_bf16_f32 v48, v124, v125
  v_cvt_pk_bf16_f32 v49, v126, v127
  v_exp_f32 v128, v128
  v_exp_f32 v129, v129
  v_exp_f32 v130, v130
  v_exp_f32 v131, v131
  s_setprio 1
  v_mfma_f32_32x32x16_bf16 v[80:95], v[30:33], v[46:49], v[80:95]
  ds_read_b128 v[30:33], v52 offset:3360
  v_cvt_pk_bf16_f32 v34, v128, v129
  v_cvt_pk_bf16_f32 v35, v130, v131
  v_exp_f32 v132, v132
  v_exp_f32 v133, v133
  v_exp_f32 v134, v134
  v_exp_f32 v135, v135
  s_setprio 2
  v_mfma_f32_32x32x8_bf16 v[96:111], v[22:23], v[10:11], v[96:111]
  ds_read_b128 v[18:21], v50 offset:8064
  ds_read_b64 v[24:25], v51 offset:8064
  v_cvt_pk_bf16_f32 v36, v132, v133
  v_cvt_pk_bf16_f32 v37, v134, v135
  v_exp_f32 v136, v136
  v_exp_f32 v137, v137
  v_exp_f32 v138, v138
  v_exp_f32 v139, v139
  s_setprio 1
  s_waitcnt lgkmcnt(3)
  v_mfma_f32_32x32x16_bf16 v[64:79], v[26:29], v[34:37], v[64:79]
  v_cvt_pk_bf16_f32 v38, v136, v137
  v_cvt_pk_bf16_f32 v39, v138, v139
  v_exp_f32 v140, v140
  v_exp_f32 v141, v141
  v_exp_f32 v142, v142
  v_exp_f32 v143, v143
  s_setprio 2
  v_mfma_f32_32x32x16_bf16 v[112:127], v[14:17], v[6:9], 0
  v_cvt_pk_bf16_f32 v40, v140, v141
  v_cvt_pk_bf16_f32 v41, v142, v143
  v_exp_f32 v144, v144
  v_exp_f32 v145, v145
  v_exp_f32 v146, v146
  v_exp_f32 v147, v147
  s_setprio 1
  s_waitcnt lgkmcnt(2)
  v_mfma_f32_32x32x16_bf16 v[64:79], v[30:33], v[38:41], v[64:79]
  v_cvt_pk_bf16_f32 v42, v144, v145
  v_cvt_pk_bf16_f32 v43, v146, v147
  v_exp_f32 v148, v148
  v_exp_f32 v149, v149
  v_exp_f32 v150, v150
  v_exp_f32 v151, v151
  s_setprio 2
  v_mfma_f32_32x32x8_bf16 v[112:127], v[22:23], v[12:13], v[112:127]
  v_cvt_pk_bf16_f32 v44, v148, v149
  v_cvt_pk_bf16_f32 v45, v150, v151
  v_exp_f32 v152, v152
  v_exp_f32 v153, v153
  v_exp_f32 v154, v154
  v_exp_f32 v155, v155
  s_setprio 1
  v_mfma_f32_32x32x16_bf16 v[80:95], v[26:29], v[42:45], v[80:95]
  ds_read_b128 v[26:29], v52 offset:5376
  v_cvt_pk_bf16_f32 v46, v152, v153
  v_cvt_pk_bf16_f32 v47, v154, v155
  v_exp_f32 v156, v156
  v_exp_f32 v157, v157
  v_exp_f32 v158, v158
  v_exp_f32 v159, v159
  s_setprio 2
  s_waitcnt lgkmcnt(1)
  v_mfma_f32_32x32x16_bf16 v[128:143], v[18:21], v[2:5], 0
  v_cvt_pk_bf16_f32 v48, v156, v157
  v_cvt_pk_bf16_f32 v49, v158, v159
  v_exp_f32 v96, v96
  v_exp_f32 v97, v97
  v_exp_f32 v98, v98
  v_exp_f32 v99, v99
  s_setprio 1
  v_mfma_f32_32x32x16_bf16 v[80:95], v[30:33], v[46:49], v[80:95]
  ds_read_b128 v[30:33], v52 offset:6048
  v_cvt_pk_bf16_f32 v34, v96, v97
  v_cvt_pk_bf16_f32 v35, v98, v99
  v_exp_f32 v100, v100
  v_exp_f32 v101, v101
  v_exp_f32 v102, v102
  v_exp_f32 v103, v103
  s_setprio 2
  v_mfma_f32_32x32x8_bf16 v[128:143], v[24:25], v[10:11], v[128:143]
  s_barrier
  v_add_u32 v50, s60, v53
  v_add_u32 v51, s60, v54
  ds_read_b128 v[14:17], v50 offset:0
  ds_read_b64 v[22:23], v51 offset:0
  v_cvt_pk_bf16_f32 v36, v100, v101
  v_cvt_pk_bf16_f32 v37, v102, v103
  v_exp_f32 v104, v104
  v_exp_f32 v105, v105
  v_exp_f32 v106, v106
  v_exp_f32 v107, v107
  s_setprio 1
  s_waitcnt lgkmcnt(3)
  v_mfma_f32_32x32x16_bf16 v[64:79], v[26:29], v[34:37], v[64:79]
  v_cvt_pk_bf16_f32 v38, v104, v105
  v_cvt_pk_bf16_f32 v39, v106, v107
  v_exp_f32 v108, v108
  v_exp_f32 v109, v109
  v_exp_f32 v110, v110
  v_exp_f32 v111, v111
  s_setprio 2
  v_mfma_f32_32x32x16_bf16 v[144:159], v[18:21], v[6:9], 0
  v_cvt_pk_bf16_f32 v40, v108, v109
  v_cvt_pk_bf16_f32 v41, v110, v111
  v_exp_f32 v112, v112
  v_exp_f32 v113, v113
  v_exp_f32 v114, v114
  v_exp_f32 v115, v115
  s_setprio 1
  s_waitcnt lgkmcnt(2)
  v_mfma_f32_32x32x16_bf16 v[64:79], v[30:33], v[38:41], v[64:79]
  v_cvt_pk_bf16_f32 v42, v112, v113
  v_cvt_pk_bf16_f32 v43, v114, v115
  v_exp_f32 v116, v116
  v_exp_f32 v117, v117
  v_exp_f32 v118, v118
  v_exp_f32 v119, v119
  s_setprio 2
  v_mfma_f32_32x32x8_bf16 v[144:159], v[24:25], v[12:13], v[144:159]
  v_cvt_pk_bf16_f32 v44, v116, v117
  v_cvt_pk_bf16_f32 v45, v118, v119
  v_exp_f32 v120, v120
  v_exp_f32 v121, v121
  v_exp_f32 v122, v122
  v_exp_f32 v123, v123
  s_setprio 1
  v_mfma_f32_32x32x16_bf16 v[80:95], v[26:29], v[42:45], v[80:95]
  ds_read_b128 v[26:29], v52 offset:8064
  v_cvt_pk_bf16_f32 v46, v120, v121
  v_cvt_pk_bf16_f32 v47, v122, v123
  v_exp_f32 v124, v124
  v_exp_f32 v125, v125
  v_exp_f32 v126, v126
  v_exp_f32 v127, v127
  s_setprio 2
  s_waitcnt lgkmcnt(1)
  v_mfma_f32_32x32x16_bf16 v[96:111], v[14:17], v[2:5], 0
  v_cvt_pk_bf16_f32 v48, v124, v125
  v_cvt_pk_bf16_f32 v49, v126, v127
  v_exp_f32 v128, v128
  v_exp_f32 v129, v129
  v_exp_f32 v130, v130
  v_exp_f32 v131, v131
  s_setprio 1
  v_mfma_f32_32x32x16_bf16 v[80:95], v[30:33], v[46:49], v[80:95]
  ds_read_b128 v[30:33], v52 offset:8736
  v_cvt_pk_bf16_f32 v34, v128, v129
  v_cvt_pk_bf16_f32 v35, v130, v131
  v_exp_f32 v132, v132
  v_exp_f32 v133, v133
  v_exp_f32 v134, v134
  v_exp_f32 v135, v135
  s_setprio 2
  v_mfma_f32_32x32x8_bf16 v[96:111], v[22:23], v[10:11], v[96:111]
  ds_read_b128 v[18:21], v50 offset:2688
  ds_read_b64 v[24:25], v51 offset:2688
  v_cvt_pk_bf16_f32 v36, v132, v133
  v_cvt_pk_bf16_f32 v37, v134, v135
  v_exp_f32 v136, v136
  v_exp_f32 v137, v137
  v_exp_f32 v138, v138
  v_exp_f32 v139, v139
  s_setprio 1
  s_waitcnt lgkmcnt(3)
  v_mfma_f32_32x32x16_bf16 v[64:79], v[26:29], v[34:37], v[64:79]
  v_cvt_pk_bf16_f32 v38, v136, v137
  v_cvt_pk_bf16_f32 v39, v138, v139
  v_exp_f32 v140, v140
  v_exp_f32 v141, v141
  v_exp_f32 v142, v142
  v_exp_f32 v143, v143
  s_setprio 2
  v_mfma_f32_32x32x16_bf16 v[112:127], v[14:17], v[6:9], 0
  v_cvt_pk_bf16_f32 v40, v140, v141
  v_cvt_pk_bf16_f32 v41, v142, v143
  v_exp_f32 v144, v144
  v_exp_f32 v145, v145
  v_exp_f32 v146, v146
  v_exp_f32 v147, v147
  s_setprio 1
  s_waitcnt lgkmcnt(2)
  v_mfma_f32_32x32x16_bf16 v[64:79], v[30:33], v[38:41], v[64:79]
  v_cvt_pk_bf16_f32 v42, v144, v145
  v_cvt_pk_bf16_f32 v43, v146, v147
  v_exp_f32 v148, v148
  v_exp_f32 v149, v149
  v_exp_f32 v150, v150
  v_exp_f32 v151, v151
  s_setprio 2
  v_mfma_f32_32x32x8_bf16 v[112:127], v[22:23], v[12:13], v[112:127]
  v_cvt_pk_bf16_f32 v44, v148, v149
  v_cvt_pk_bf16_f32 v45, v150, v151
  v_exp_f32 v152, v152
  v_exp_f32 v153, v153
  v_exp_f32 v154, v154
  v_exp_f32 v155, v155
  s_setprio 1
  v_mfma_f32_32x32x16_bf16 v[80:95], v[26:29], v[42:45], v[80:95]
  v_add_u32 v52, s60, v55
  ds_read_b128 v[26:29], v52 offset:0
  v_cvt_pk_bf16_f32 v46, v152, v153
  v_cvt_pk_bf16_f32 v47, v154, v155
  v_exp_f32 v156, v156
  v_exp_f32 v157, v157
  v_exp_f32 v158, v158
  v_exp_f32 v159, v159
  s_mov_b32 s59, s60
  s_add_u32 s58, s58, 1
  s_cmp_lt_u32 s58, 8
  s_cbranch_scc1 attn_kernel_loop
  v_cvt_pk_bf16_f32 v48, v156, v157
  v_cvt_pk_bf16_f32 v49, v158, v159
  s_nop 1
  v_mfma_f32_32x32x16_bf16 v[80:95], v[30:33], v[46:49], v[80:95]
  s_setprio 3
  s_mov_b32 s61, 0
  s_movk_i32 s72, 512
attn_kernel_publish:
  v_add_u32 v60, s64, v56
  v_add_u32 v61, s65, v56
  s_waitcnt lgkmcnt(0)
  s_cmp_eq_u32 s49, 0
  s_cbranch_scc1 attn_kernel_send1
  ds_write_b128 v60, v[64:67] offset:0
  ds_write_b128 v60, v[68:71] offset:1024
  ds_write_b128 v60, v[72:75] offset:2048
  s_nop 0
  v_mov_b32 v96, v80
  v_mov_b32 v97, v81
  v_mov_b32 v98, v82
  v_mov_b32 v99, v83
  v_mov_b32 v100, v84
  v_mov_b32 v101, v85
  v_mov_b32 v102, v86
  v_mov_b32 v103, v87
  v_mov_b32 v104, v88
  v_mov_b32 v105, v89
  v_mov_b32 v106, v90
  v_mov_b32 v107, v91
  s_branch attn_kernel_sent
attn_kernel_send1:
  s_nop 3
  ds_write_b128 v60, v[80:83] offset:0
  ds_write_b128 v60, v[84:87] offset:1024
  ds_write_b128 v60, v[88:91] offset:2048
  v_mov_b32 v96, v64
  v_mov_b32 v97, v65
  v_mov_b32 v98, v66
  v_mov_b32 v99, v67
  v_mov_b32 v100, v68
  v_mov_b32 v101, v69
  v_mov_b32 v102, v70
  v_mov_b32 v103, v71
  v_mov_b32 v104, v72
  v_mov_b32 v105, v73
  v_mov_b32 v106, v74
  v_mov_b32 v107, v75
attn_kernel_sent:
  v_add_f32 v112, abs(v64), abs(v80)
  v_add_f32 v113, abs(v65), abs(v81)
  v_add_f32 v114, abs(v66), abs(v82)
  v_add_f32 v115, abs(v67), abs(v83)
  v_add_f32 v112, v112, abs(v68)
  v_add_f32 v112, v112, abs(v84)
  v_add_f32 v113, v113, abs(v69)
  v_add_f32 v113, v113, abs(v85)
  v_add_f32 v114, v114, abs(v70)
  v_add_f32 v114, v114, abs(v86)
  v_add_f32 v115, v115, abs(v71)
  v_add_f32 v115, v115, abs(v87)
  v_add_f32 v112, v112, abs(v72)
  v_add_f32 v112, v112, abs(v88)
  v_add_f32 v113, v113, abs(v73)
  v_add_f32 v113, v113, abs(v89)
  v_add_f32 v114, v114, abs(v74)
  v_add_f32 v114, v114, abs(v90)
  v_add_f32 v115, v115, abs(v75)
  v_add_f32 v115, v115, abs(v91)
  v_add_f32 v112, v112, v113
  v_add_f32 v114, v114, v115
  v_add_f32 v112, v112, v114
  s_mov_b32 s62, 0x71800000
  v_cmp_nlt_f32 vcc, v112, s62
  s_nop 0
  s_cmp_lg_u64 vcc, 0
  s_cselect_b32 s62, 0x10000, 0
  s_andn2_b32 s62, s62, s61
  s_add_u32 s62, s62, 1
  v_mov_b32 v58, s62
  s_waitcnt lgkmcnt(0)
  ds_add_u32 v57, v58 offset:4
  s_setprio 1
attn_kernel_pubspin:
  ds_read_b32 v58, v57 offset:4
  s_waitcnt lgkmcnt(0)
  v_readfirstlane_b32 s63, v58
  s_nop 0
  s_and_b32 s62, s63, 0xffff
  s_cmp_ge_u32 s62, s72
  s_cbranch_scc1 attn_kernel_pubspin_d
  s_sleep 1
  s_branch attn_kernel_pubspin
attn_kernel_pubspin_d:
  s_setprio 3
  ds_read_b128 v[112:115], v61 offset:0
  ds_read_b128 v[116:119], v61 offset:1024
  ds_read_b128 v[120:123], v61 offset:2048
  s_lshr_b32 s63, s63, 16
  s_andn2_b32 s63, s63, s61
  s_cmp_lg_u32 s63, 0
  s_cbranch_scc1 attn_kernel_fallback
  s_waitcnt lgkmcnt(0)
  v_add_f32 v96, v96, v112
  v_add_f32 v97, v97, v113
  v_add_f32 v98, v98, v114
  v_add_f32 v99, v99, v115
  v_add_f32 v100, v100, v116
  v_add_f32 v101, v101, v117
  v_add_f32 v102, v102, v118
  v_add_f32 v103, v103, v119
  v_add_f32 v104, v104, v120
  v_add_f32 v105, v105, v121
  v_add_f32 v106, v106, v122
  v_add_f32 v107, v107, v123
  v_mov_b32 v58, v104
  v_mov_b32 v59, v104
  s_nop 1
  v_permlane32_swap_b32 v58, v59
  v_rcp_f32 v59, v59
  s_nop 0
  v_mul_f32 v96, v96, v59
  v_mul_f32 v97, v97, v59
  v_mul_f32 v98, v98, v59
  v_mul_f32 v99, v99, v59
  v_mul_f32 v100, v100, v59
  v_mul_f32 v101, v101, v59
  v_mul_f32 v102, v102, v59
  v_mul_f32 v103, v103, v59
  v_mul_f32 v104, v104, v59
  v_mul_f32 v105, v105, v59
  v_mul_f32 v106, v106, v59
  v_mul_f32 v107, v107, v59
  v_cvt_pk_bf16_f32 v112, v96, v97
  v_cvt_pk_bf16_f32 v113, v98, v99
  v_cvt_pk_bf16_f32 v114, v100, v101
  v_cvt_pk_bf16_f32 v115, v102, v103
  v_cvt_pk_bf16_f32 v116, v104, v105
  v_cvt_pk_bf16_f32 v117, v106, v107
  v_permlane32_swap_b32 v112, v114
  v_permlane32_swap_b32 v113, v115
  buffer_store_dwordx4 v[112:115], v160, s[8:11], s66 offen sc1
  s_mov_b64 exec, s[50:51]
  buffer_store_dwordx2 v[116:117], v161, s[8:11], s67 offen sc1
  s_mov_b64 exec, -1
  s_endpgm
attn_kernel_fallback:
  s_mov_b32 s61, -1
  s_movk_i32 s72, 1024
  s_waitcnt lgkmcnt(0)
  s_mov_b64 exec, s[54:55]
  v_mov_b32 v10, 0
  v_mov_b32 v12, 0
  s_mov_b64 exec, -1
  s_mul_i32 s62, s46, 172032
  s_mul_i32 s63, s49, 10752
  v_subrev_u32 v51, s63, v54
  v_subrev_u32 v52, s63, v55
  v_mov_b32 v60, 0xff800000
  v_mov_b32 v61, 0xff800000
  s_mov_b32 s58, 0
  s_mov_b32 s59, s62
attn_kernel_fb1:
  buffer_load_dwordx4 v[14:17], v56, s[8:11], s59 offen
  buffer_load_dwordx2 v[22:23], v51, s[8:11], s59 offen
  s_waitcnt vmcnt(0)
  v_mfma_f32_32x32x16_bf16 v[96:111], v[14:17], v[2:5], 0
  v_mfma_f32_32x32x8_bf16 v[96:111], v[22:23], v[10:11], v[96:111]
  v_mfma_f32_32x32x16_bf16 v[112:127], v[14:17], v[6:9], 0
  v_mfma_f32_32x32x8_bf16 v[112:127], v[22:23], v[12:13], v[112:127]
  s_nop 9
  v_max3_f32 v60, v60, v96, v97
  v_max3_f32 v60, v60, v98, v99
  v_max3_f32 v60, v60, v100, v101
  v_max3_f32 v60, v60, v102, v103
  v_max3_f32 v60, v60, v104, v105
  v_max3_f32 v60, v60, v106, v107
  v_max3_f32 v60, v60, v108, v109
  v_max3_f32 v60, v60, v110, v111
  v_max3_f32 v61, v61, v112, v113
  v_max3_f32 v61, v61, v114, v115
  v_max3_f32 v61, v61, v116, v117
  v_max3_f32 v61, v61, v118, v119
  v_max3_f32 v61, v61, v120, v121
  v_max3_f32 v61, v61, v122, v123
  v_max3_f32 v61, v61, v124, v125
  v_max3_f32 v61, v61, v126, v127
  s_add_u32 s59, s59, 2688
  s_add_u32 s58, s58, 1
  s_cmp_lt_u32 s58, 64
  s_cbranch_scc1 attn_kernel_fb1
  v_mov_b32 v59, v60
  s_nop 1
  v_permlane32_swap_b32 v60, v59
  v_max_f32 v60, v60, v59
  v_sub_f32 v60, 0, v60
  v_cvt_pk_bf16_f32 v60, v60, 0
  s_mov_b64 exec, s[54:55]
  v_mov_b32 v10, v60
  s_mov_b64 exec, -1
  v_mov_b32 v59, v61
  s_nop 1
  v_permlane32_swap_b32 v61, v59
  v_max_f32 v61, v61, v59
  v_sub_f32 v61, 0, v61
  v_cvt_pk_bf16_f32 v61, v61, 0
  s_mov_b64 exec, s[54:55]
  v_mov_b32 v12, v61
  s_mov_b64 exec, -1
  v_mov_b32 v64, 0
  v_mov_b32 v65, 0
  v_mov_b32 v66, 0
  v_mov_b32 v67, 0
  v_mov_b32 v68, 0
  v_mov_b32 v69, 0
  v_mov_b32 v70, 0
  v_mov_b32 v71, 0
  v_mov_b32 v72, 0
  v_mov_b32 v73, 0
  v_mov_b32 v74, 0
  v_mov_b32 v75, 0
  v_mov_b32 v76, 0
  v_mov_b32 v77, 0
  v_mov_b32 v78, 0
  v_mov_b32 v79, 0
  v_mov_b32 v80, 0
  v_mov_b32 v81, 0
  v_mov_b32 v82, 0
  v_mov_b32 v83, 0
  v_mov_b32 v84, 0
  v_mov_b32 v85, 0
  v_mov_b32 v86, 0
  v_mov_b32 v87, 0
  v_mov_b32 v88, 0
  v_mov_b32 v89, 0
  v_mov_b32 v90, 0
  v_mov_b32 v91, 0
  v_mov_b32 v92, 0
  v_mov_b32 v93, 0
  v_mov_b32 v94, 0
  v_mov_b32 v95, 0
  s_mov_b32 s58, 0
  s_add_u32 s62, s62, s63
attn_kernel_fb2:
  s_lshr_b32 s59, s58, 2
  s_mul_i32 s59, s59, 21504
  s_and_b32 s60, s58, 3
  s_mul_i32 s60, s60, 2688
  s_add_u32 s59, s59, s60
  s_add_u32 s59, s59, s62
  buffer_load_dwordx4 v[14:17], v56, s[8:11], s59 offen
  buffer_load_dwordx2 v[22:23], v51, s[8:11], s59 offen
  buffer_load_dwordx4 v[26:29], v52, s[8:11], s59 offen
  buffer_load_dwordx4 v[30:33], v52, s[8:11], s59 offen offset:672
  s_waitcnt vmcnt(0)
  v_mfma_f32_32x32x16_bf16 v[96:111], v[14:17], v[2:5], 0
  v_mfma_f32_32x32x8_bf16 v[96:111], v[22:23], v[10:11], v[96:111]
  v_mfma_f32_32x32x16_bf16 v[112:127], v[14:17], v[6:9], 0
  v_mfma_f32_32x32x8_bf16 v[112:127], v[22:23], v[12:13], v[112:127]
  s_nop 9
  v_exp_f32 v96, v96
  v_exp_f32 v97, v97
  v_exp_f32 v98, v98
  v_exp_f32 v99, v99
  v_exp_f32 v100, v100
  v_exp_f32 v101, v101
  v_exp_f32 v102, v102
  v_exp_f32 v103, v103
  v_exp_f32 v104, v104
  v_exp_f32 v105, v105
  v_exp_f32 v106, v106
  v_exp_f32 v107, v107
  v_exp_f32 v108, v108
  v_exp_f32 v109, v109
  v_exp_f32 v110, v110
  v_exp_f32 v111, v111
  v_cvt_pk_bf16_f32 v34, v96, v97
  v_cvt_pk_bf16_f32 v35, v98, v99
  v_cvt_pk_bf16_f32 v36, v100, v101
  v_cvt_pk_bf16_f32 v37, v102, v103
  v_cvt_pk_bf16_f32 v38, v104, v105
  v_cvt_pk_bf16_f32 v39, v106, v107
  v_cvt_pk_bf16_f32 v40, v108, v109
  v_cvt_pk_bf16_f32 v41, v110, v111
  v_mfma_f32_32x32x16_bf16 v[64:79], v[26:29], v[34:37], v[64:79]
  s_nop 0
  v_mfma_f32_32x32x16_bf16 v[64:79], v[30:33], v[38:41], v[64:79]
  v_exp_f32 v112, v112
  v_exp_f32 v113, v113
  v_exp_f32 v114, v114
  v_exp_f32 v115, v115
  v_exp_f32 v116, v116
  v_exp_f32 v117, v117
  v_exp_f32 v118, v118
  v_exp_f32 v119, v119
  v_exp_f32 v120, v120
  v_exp_f32 v121, v121
  v_exp_f32 v122, v122
  v_exp_f32 v123, v123
  v_exp_f32 v124, v124
  v_exp_f32 v125, v125
  v_exp_f32 v126, v126
  v_exp_f32 v127, v127
  v_cvt_pk_bf16_f32 v42, v112, v113
  v_cvt_pk_bf16_f32 v43, v114, v115
  v_cvt_pk_bf16_f32 v44, v116, v117
  v_cvt_pk_bf16_f32 v45, v118, v119
  v_cvt_pk_bf16_f32 v46, v120, v121
  v_cvt_pk_bf16_f32 v47, v122, v123
  v_cvt_pk_bf16_f32 v48, v124, v125
  v_cvt_pk_bf16_f32 v49, v126, v127
  v_mfma_f32_32x32x16_bf16 v[80:95], v[26:29], v[42:45], v[80:95]
  s_nop 0
  v_mfma_f32_32x32x16_bf16 v[80:95], v[30:33], v[46:49], v[80:95]
  s_add_u32 s58, s58, 1
  s_cmp_lt_u32 s58, 32
  s_cbranch_scc1 attn_kernel_fb2
  s_branch attn_kernel_publish
attn_kernel_aux:
  s_sub_u32 s3, s3, 8
  v_lshlrev_b32 v2, 4, v1
  s_mul_i32 s50, s46, 172032
  s_lshl_b32 s35, s3, 10
  s_add_u32 s50, s50, s35
  s_setprio 3
  s_add_u32 m0, s35, 0
  s_add_u32 s52, s50, 0
  buffer_load_dwordx4 v2, s[8:11], s52 offen lds
  s_add_u32 m0, s35, 4096
  s_add_u32 s52, s50, 4096
  buffer_load_dwordx4 v2, s[8:11], s52 offen lds
  s_add_u32 m0, s35, 8192
  s_add_u32 s52, s50, 8192
  buffer_load_dwordx4 v2, s[8:11], s52 offen lds
  s_add_u32 m0, s35, 12288
  s_add_u32 s52, s50, 12288
  buffer_load_dwordx4 v2, s[8:11], s52 offen lds
  s_add_u32 m0, s35, 16384
  s_add_u32 s52, s50, 16384
  buffer_load_dwordx4 v2, s[8:11], s52 offen lds
  s_cmp_lg_u32 s3, 0
  s_cbranch_scc1 attn_kernel_kv5_0
  s_add_u32 m0, s35, 20480
  s_add_u32 s52, s50, 20480
  buffer_load_dwordx4 v2, s[8:11], s52 offen lds
attn_kernel_kv5_0:
  s_setprio 0
  s_setprio 3
  s_add_u32 m0, s35, 21504
  s_add_u32 s52, s50, 21504
  buffer_load_dwordx4 v2, s[8:11], s52 offen lds
  s_add_u32 m0, s35, 25600
  s_add_u32 s52, s50, 25600
  buffer_load_dwordx4 v2, s[8:11], s52 offen lds
  s_add_u32 m0, s35, 29696
  s_add_u32 s52, s50, 29696
  buffer_load_dwordx4 v2, s[8:11], s52 offen lds
  s_add_u32 m0, s35, 33792
  s_add_u32 s52, s50, 33792
  buffer_load_dwordx4 v2, s[8:11], s52 offen lds
  s_add_u32 m0, s35, 37888
  s_add_u32 s52, s50, 37888
  buffer_load_dwordx4 v2, s[8:11], s52 offen lds
  s_cmp_lg_u32 s3, 0
  s_cbranch_scc1 attn_kernel_kv5_1
  s_add_u32 m0, s35, 41984
  s_add_u32 s52, s50, 41984
  buffer_load_dwordx4 v2, s[8:11], s52 offen lds
attn_kernel_kv5_1:
  s_setprio 0
  v_mov_b32 v60, 161792
  v_mov_b32 v62, 0
  v_mov_b32 v63, 0
  ds_write_b64 v60, v[62:63]
  ds_write_b64 v60, v[62:63] offset:8
  s_mov_b32 s12, s36
  s_and_b32 s13, s37, 0xffff
  s_mov_b32 s14, 2621440
  s_mov_b32 s15, 0x00020000
  s_lshl_b32 s64, s2, 1
  s_add_u32 s65, s64, 1
  s_lshr_b32 s66, s2, 1
  s_add_u32 s66, s66, 512
  s_lshl_b32 s67, s2, 2
  s_load_dword s68, s[38:39], s67
  s_lshr_b32 s67, s66, 1
  s_lshl_b32 s67, s67, 2
  s_load_dword s70, s[38:39], s67
  s_cmp_lt_u32 s3, 2
  s_cbranch_scc1 attn_kernel_ha_addr
  v_lshrrev_b32 v4, 3, v1
  v_and_b32 v4, 2, v4
  v_xor_b32 v4, v4, v1
  v_lshlrev_b32 v3, 4, v4
  s_sub_u32 s67, 3, s3
  s_lshl_b32 s67, s67, 1
  v_add_u32 v3, s67, v3
  s_branch attn_kernel_addr_done
attn_kernel_ha_addr:
  s_lshl_b32 s67, s3, 2
  s_sub_u32 s67, s67, 60
  v_add_u32 v3, s67, v2
attn_kernel_addr_done:
  v_add_u32 v10, 64, v3
  s_mov_b32 s71, 0
  s_cmp_eq_u32 s3, 1
  s_cselect_b32 s71, 4224, s71
  s_cmp_eq_u32 s3, 2
  s_cselect_b32 s71, 8448, s71
  s_cmp_eq_u32 s3, 3
  s_cselect_b32 s71, 13064, s71
  s_mov_b64 s[72:73], -1
  s_mov_b32 s74, 0x0fffffff
  s_mov_b32 s75, 0
  s_cmp_lt_u32 s3, 2
  s_cselect_b32 s72, 0xfffffff0, s72
  s_cselect_b32 s74, 0xf, s74
  s_waitcnt lgkmcnt(0)
  s_and_b32 s67, s68, 0xffff
  s_lshr_b32 s68, s68, 16
  s_and_b32 s69, s66, 1
  s_lshl_b32 s69, s69, 4
  s_lshr_b32 s69, s70, s69
  s_and_b32 s69, s69, 0xffff
  v_and_b32 v4, 15, v1
  v_lshrrev_b32 v5, 4, v1
  v_and_b32 v6, 1, v4
  v_and_b32 v7, 14, v4
  v_lshlrev_b32 v7, 2, v7
  v_lshl_add_u32 v7, v5, 4, v7
  v_mul_u32_u24 v8, 4224, v6
  v_add_u32 v7, v7, v8
  s_lshl_b32 s76, s3, 7
  v_add_u32 v7, s76, v7
  v_lshrrev_b32 v8, 1, v4
  v_lshlrev_b32 v8, 2, v8
  v_sub_u32 v8, v5, v8
  s_lshl_b32 s76, s3, 3
  s_add_u32 s76, s76, 28
  v_add_u32 v8, s76, v8
  v_mul_u32_u24 v11, 4616, v6
  v_add_u32 v11, 8448, v11
  v_lshrrev_b32 v9, 3, v8
  v_and_b32 v9, 2, v9
  v_xor_b32 v9, v9, v8
  v_lshl_add_u32 v12, v9, 4, v11
  v_add_u32 v8, 4, v8
  v_lshrrev_b32 v9, 3, v8
  v_and_b32 v9, 2, v9
  v_xor_b32 v9, v9, v8
  v_lshl_add_u32 v13, v9, 4, v11
  v_lshlrev_b32 v8, 1, v4
  v_lshl_add_u32 v8, v5, 3, v8
  v_cmp_eq_u32 vcc, 30, v8
  v_mov_b32 v9, 0xffff
  s_nop 0
  v_cndmask_b32 v14, 0, v9, vcc
  v_cmp_eq_u32 vcc, 28, v8
  v_mov_b32 v9, 0xffff
  s_nop 0
  v_cndmask_b32 v15, 0, v9, vcc
  v_cmp_eq_u32 vcc, 26, v8
  v_mov_b32 v9, 0xffff
  s_nop 0
  v_cndmask_b32 v16, 0, v9, vcc
  v_cmp_eq_u32 vcc, 24, v8
  v_mov_b32 v9, 0xffff
  s_nop 0
  v_cndmask_b32 v17, 0, v9, vcc
  s_bfe_u32 s48, s2, 0x20001
  s_and_b32 s49, s2, 1
  s_lshl_b32 s49, s49, 2
  s_bfe_u32 s55, s2, 0x20003
  s_add_u32 s49, s49, s55
  s_mul_i32 s51, s49, 102400
  s_add_u32 s51, s51, 16171008
  v_mov_b32 v60, 161792
  v_mov_b32 v61, 1
  s_setprio 0
  s_waitcnt vmcnt(5)
  s_waitcnt lgkmcnt(0)
  s_barrier
  s_setprio 3
  s_lshl_b32 s52, s64, 12
  v_mov_b32 v48, 0
  buffer_load_dwordx2 v[46:47], v48, s[12:15], s52 offen
  s_mul_i32 s53, s64, 4352
  s_add_u32 s53, s53, 8126464
  s_add_u32 s16, s4, s53
  s_addc_u32 s17, s5, 0
  s_and_b32 s17, s17, 0xffff
  s_mov_b32 s18, 4112
  s_mov_b32 s19, 0x00020000
  s_add_u32 s53, s71, 64512
  s_cmp_lt_u32 s3, 2
  s_cbranch_scc1 attn_kernel_ci0hu_ha
  s_add_u32 m0, s53, 0
  s_mov_b32 s54, 0
  buffer_load_dwordx4 v3, s[16:19], s54 offen lds
  s_add_u32 m0, s53, 1024
  s_mov_b32 s54, 1024
  buffer_load_dwordx4 v3, s[16:19], s54 offen lds
  s_add_u32 m0, s53, 2048
  s_mov_b32 s54, 2048
  buffer_load_dwordx4 v3, s[16:19], s54 offen lds
  s_add_u32 m0, s53, 3072
  s_mov_b32 s54, 3072
  buffer_load_dwordx4 v3, s[16:19], s54 offen lds
  s_mov_b64 exec, s[74:75]
  s_add_u32 m0, s53, 4096
  s_mov_b32 s54, 4096
  buffer_load_dwordx4 v3, s[16:19], s54 offen lds
  s_branch attn_kernel_ci0hu_done
attn_kernel_ci0hu_ha:
  s_mov_b64 exec, s[72:73]
  s_add_u32 m0, s53, 0
  s_add_u32 s54, s52, 0
  buffer_load_dwordx4 v3, s[12:15], s54 offen lds
  s_mov_b64 exec, -1
  s_add_u32 m0, s53, 1024
  s_add_u32 s54, s52, 960
  buffer_load_dwordx4 v10, s[12:15], s54 offen lds
  s_add_u32 m0, s53, 2048
  s_add_u32 s54, s52, 1984
  buffer_load_dwordx4 v10, s[12:15], s54 offen lds
  s_add_u32 m0, s53, 3072
  s_add_u32 s54, s52, 3008
  buffer_load_dwordx4 v10, s[12:15], s54 offen lds
  s_mov_b64 exec, s[74:75]
  s_add_u32 m0, s53, 4096
  s_add_u32 s54, s52, 4032
  buffer_load_dwordx4 v10, s[12:15], s54 offen lds
attn_kernel_ci0hu_done:
  s_mov_b64 exec, -1
  s_setprio 0
  s_setprio 3
  s_add_u32 m0, s35, 43008
  s_add_u32 s52, s50, 43008
  buffer_load_dwordx4 v2, s[8:11], s52 offen lds
  s_add_u32 m0, s35, 47104
  s_add_u32 s52, s50, 47104
  buffer_load_dwordx4 v2, s[8:11], s52 offen lds
  s_add_u32 m0, s35, 51200
  s_add_u32 s52, s50, 51200
  buffer_load_dwordx4 v2, s[8:11], s52 offen lds
  s_add_u32 m0, s35, 55296
  s_add_u32 s52, s50, 55296
  buffer_load_dwordx4 v2, s[8:11], s52 offen lds
  s_add_u32 m0, s35, 59392
  s_add_u32 s52, s50, 59392
  buffer_load_dwordx4 v2, s[8:11], s52 offen lds
  s_cmp_lg_u32 s3, 0
  s_cbranch_scc1 attn_kernel_kv5_2
  s_add_u32 m0, s35, 63488
  s_add_u32 s52, s50, 63488
  buffer_load_dwordx4 v2, s[8:11], s52 offen lds
attn_kernel_kv5_2:
  s_setprio 0
  v_and_b32 v18, 31, v1
  v_lshrrev_b32 v19, 3, v18
  v_lshlrev_b32 v19, 16, v19
  v_and_b32 v20, 1, v18
  v_lshlrev_b32 v20, 2, v20
  v_bfe_u32 v21, v18, 1, 2
  v_add_u32 v20, v20, v21
  v_lshl_add_u32 v19, v20, 4, v19
  v_lshrrev_b32 v20, 5, v1
  v_lshl_add_u32 v19, v20, 8, v19
  v_mov_b32 v22, -1
  v_mov_b32 v23, -1
  v_mov_b32 v24, -1
  v_mov_b32 v25, -1
  s_lshl_b32 s52, s47, 18
  s_lshl_b32 s53, s3, 14
  s_add_u32 s52, s52, s53
  s_lshl_b32 s53, s46, 9
  s_add_u32 s52, s52, s53
  s_add_u32 s52, s52, 10928128
  buffer_store_dwordx4 v[22:25], v19, s[8:11], s52 offen sc1
  buffer_store_dwordx4 v[22:25], v19, s[8:11], s52 offen offset:128 sc1
  s_lshl_b32 s52, s46, 6
  s_lshl_b32 s53, s47, 3
  s_add_u32 s52, s52, s53
  s_lshl_b32 s53, s3, 1
  s_add_u32 s52, s52, s53
  s_lshl_b32 s52, s52, 8
  s_add_u32 s52, s52, 13025280
  v_lshlrev_b32 v18, 3, v1
  buffer_store_dwordx2 v[22:23], v18, s[8:11], s52 offen sc1
  s_setprio 3
  s_lshl_b32 s52, s65, 12
  v_mov_b32 v48, 0
  buffer_load_dwordx2 v[50:51], v48, s[12:15], s52 offen
  s_mul_i32 s53, s65, 4352
  s_add_u32 s53, s53, 8126464
  s_add_u32 s16, s4, s53
  s_addc_u32 s17, s5, 0
  s_and_b32 s17, s17, 0xffff
  s_mov_b32 s18, 4112
  s_mov_b32 s19, 0x00020000
  s_add_u32 s53, s71, 82176
  s_cmp_lt_u32 s3, 2
  s_cbranch_scc1 attn_kernel_ci1hu_ha
  s_add_u32 m0, s53, 0
  s_mov_b32 s54, 0
  buffer_load_dwordx4 v3, s[16:19], s54 offen lds
  s_add_u32 m0, s53, 1024
  s_mov_b32 s54, 1024
  buffer_load_dwordx4 v3, s[16:19], s54 offen lds
  s_add_u32 m0, s53, 2048
  s_mov_b32 s54, 2048
  buffer_load_dwordx4 v3, s[16:19], s54 offen lds
  s_add_u32 m0, s53, 3072
  s_mov_b32 s54, 3072
  buffer_load_dwordx4 v3, s[16:19], s54 offen lds
  s_mov_b64 exec, s[74:75]
  s_add_u32 m0, s53, 4096
  s_mov_b32 s54, 4096
  buffer_load_dwordx4 v3, s[16:19], s54 offen lds
  s_branch attn_kernel_ci1hu_done
attn_kernel_ci1hu_ha:
  s_mov_b64 exec, s[72:73]
  s_add_u32 m0, s53, 0
  s_add_u32 s54, s52, 0
  buffer_load_dwordx4 v3, s[12:15], s54 offen lds
  s_mov_b64 exec, -1
  s_add_u32 m0, s53, 1024
  s_add_u32 s54, s52, 960
  buffer_load_dwordx4 v10, s[12:15], s54 offen lds
  s_add_u32 m0, s53, 2048
  s_add_u32 s54, s52, 1984
  buffer_load_dwordx4 v10, s[12:15], s54 offen lds
  s_add_u32 m0, s53, 3072
  s_add_u32 s54, s52, 3008
  buffer_load_dwordx4 v10, s[12:15], s54 offen lds
  s_mov_b64 exec, s[74:75]
  s_add_u32 m0, s53, 4096
  s_add_u32 s54, s52, 4032
  buffer_load_dwordx4 v10, s[12:15], s54 offen lds
attn_kernel_ci1hu_done:
  s_mov_b64 exec, -1
  s_setprio 0
  s_waitcnt vmcnt(19)
  s_cmp_ge_u32 s3, 2
  s_cbranch_scc1 attn_kernel_fx0
  s_sub_u32 s52, 15, s3
  v_cmp_eq_u32 vcc, s52, v1
  s_nop 1
  v_cndmask_b32 v48, 0, v46, vcc
  s_add_u32 s52, s52, 1
  v_cmp_eq_u32 vcc, s52, v1
  s_nop 1
  v_cndmask_b32 v48, v48, v47, vcc
  s_add_u32 s52, s71, 64512
  v_lshlrev_b32 v49, 2, v1
  v_add_u32 v49, s52, v49
  s_mov_b64 exec, 0xffff
  ds_write_b32 v49, v48
  s_mov_b64 exec, -1
attn_kernel_fx0:
  s_waitcnt vmcnt(14)
  s_waitcnt lgkmcnt(0)
  s_barrier
  s_setprio 3
  v_add_u32 v58, 64512, v7
  v_add_u32 v59, 64512, v12
  ds_read_b64 v[96:97], v58 offset:0
  ds_read_b64 v[98:99], v58 offset:8
  ds_read_b64 v[128:129], v59 offset:3584
  ds_read_b64 v[130:131], v59 offset:3592
  ds_read_b64 v[100:101], v58 offset:512
  ds_read_b64 v[102:103], v58 offset:520
  ds_read_b64 v[132:133], v59 offset:3072
  ds_read_b64 v[134:135], v59 offset:3080
  ds_read_b64 v[104:105], v58 offset:1024
  ds_read_b64 v[106:107], v58 offset:1032
  ds_read_b64 v[136:137], v59 offset:2560
  ds_read_b64 v[138:139], v59 offset:2568
  ds_read_b64 v[108:109], v58 offset:1536
  ds_read_b64 v[110:111], v58 offset:1544
  ds_read_b64 v[140:141], v59 offset:2048
  ds_read_b64 v[142:143], v59 offset:2056
  ds_read_b64 v[112:113], v58 offset:2048
  ds_read_b64 v[114:115], v58 offset:2056
  ds_read_b64 v[144:145], v59 offset:1536
  ds_read_b64 v[146:147], v59 offset:1544
  ds_read_b64 v[116:117], v58 offset:2560
  ds_read_b64 v[118:119], v58 offset:2568
  ds_read_b64 v[148:149], v59 offset:1024
  ds_read_b64 v[150:151], v59 offset:1032
  ds_read_b64 v[120:121], v58 offset:3072
  ds_read_b64 v[122:123], v58 offset:3080
  ds_read_b64 v[152:153], v59 offset:512
  ds_read_b64 v[154:155], v59 offset:520
  ds_read_b64 v[124:125], v58 offset:3584
  ds_read_b64 v[126:127], v58 offset:3592
  ds_read_b64 v[156:157], v59 offset:0
  ds_read_b64 v[158:159], v59 offset:8
  s_setprio 0
  s_waitcnt lgkmcnt(15)
  v_mfma_f32_16x16x32_bf16 v[64:67], v[96:99], v[128:131], 0
  s_waitcnt lgkmcnt(15)
  v_mfma_f32_16x16x32_bf16 v[68:71], v[100:103], v[128:131], 0
  s_waitcnt lgkmcnt(15)
  v_mfma_f32_16x16x32_bf16 v[68:71], v[96:99], v[132:135], v[68:71]
  v_mfma_f32_16x16x32_bf16 v[72:75], v[100:103], v[132:135], 0
  s_waitcnt lgkmcnt(15)
  v_mfma_f32_16x16x32_bf16 v[72:75], v[104:107], v[128:131], v[72:75]
  v_mfma_f32_16x16x32_bf16 v[76:79], v[104:107], v[132:135], 0
  s_waitcnt lgkmcnt(15)
  v_mfma_f32_16x16x32_bf16 v[72:75], v[96:99], v[136:139], v[72:75]
  v_mfma_f32_16x16x32_bf16 v[76:79], v[100:103], v[136:139], v[76:79]
  v_mfma_f32_16x16x32_bf16 v[80:83], v[104:107], v[136:139], 0
  s_waitcnt lgkmcnt(15)
  v_mfma_f32_16x16x32_bf16 v[76:79], v[108:111], v[128:131], v[76:79]
  v_mfma_f32_16x16x32_bf16 v[80:83], v[108:111], v[132:135], v[80:83]
  v_mfma_f32_16x16x32_bf16 v[84:87], v[108:111], v[136:139], 0
  s_waitcnt lgkmcnt(15)
  v_mfma_f32_16x16x32_bf16 v[76:79], v[96:99], v[140:143], v[76:79]
  v_mfma_f32_16x16x32_bf16 v[80:83], v[100:103], v[140:143], v[80:83]
  v_mfma_f32_16x16x32_bf16 v[84:87], v[104:107], v[140:143], v[84:87]
  v_mfma_f32_16x16x32_bf16 v[88:91], v[108:111], v[140:143], 0
  s_waitcnt lgkmcnt(14)
  v_mfma_f32_16x16x32_bf16 v[80:83], v[112:115], v[128:131], v[80:83]
  v_mfma_f32_16x16x32_bf16 v[84:87], v[112:115], v[132:135], v[84:87]
  v_mfma_f32_16x16x32_bf16 v[88:91], v[112:115], v[136:139], v[88:91]
  v_mfma_f32_16x16x32_bf16 v[92:95], v[112:115], v[140:143], 0
  s_waitcnt lgkmcnt(12)
  v_mfma_f32_16x16x32_bf16 v[80:83], v[96:99], v[144:147], v[80:83]
  v_mfma_f32_16x16x32_bf16 v[84:87], v[100:103], v[144:147], v[84:87]
  v_mfma_f32_16x16x32_bf16 v[88:91], v[104:107], v[144:147], v[88:91]
  v_mfma_f32_16x16x32_bf16 v[92:95], v[108:111], v[144:147], v[92:95]
  s_waitcnt lgkmcnt(10)
  v_mfma_f32_16x16x32_bf16 v[84:87], v[116:119], v[128:131], v[84:87]
  v_mfma_f32_16x16x32_bf16 v[88:91], v[116:119], v[132:135], v[88:91]
  v_mfma_f32_16x16x32_bf16 v[92:95], v[116:119], v[136:139], v[92:95]
  s_waitcnt lgkmcnt(8)
  v_mfma_f32_16x16x32_bf16 v[84:87], v[96:99], v[148:151], v[84:87]
  v_mfma_f32_16x16x32_bf16 v[88:91], v[100:103], v[148:151], v[88:91]
  v_mfma_f32_16x16x32_bf16 v[92:95], v[104:107], v[148:151], v[92:95]
  s_waitcnt lgkmcnt(6)
  v_mfma_f32_16x16x32_bf16 v[88:91], v[120:123], v[128:131], v[88:91]
  v_mfma_f32_16x16x32_bf16 v[92:95], v[120:123], v[132:135], v[92:95]
  s_waitcnt lgkmcnt(4)
  v_mfma_f32_16x16x32_bf16 v[88:91], v[96:99], v[152:155], v[88:91]
  v_mfma_f32_16x16x32_bf16 v[92:95], v[100:103], v[152:155], v[92:95]
  s_waitcnt lgkmcnt(2)
  v_mfma_f32_16x16x32_bf16 v[92:95], v[124:127], v[128:131], v[92:95]
  s_waitcnt lgkmcnt(0)
  v_mfma_f32_16x16x32_bf16 v[92:95], v[96:99], v[156:159], v[92:95]
  s_cmp_lg_u32 s3, 0
  s_cbranch_scc1 attn_kernel_dt0
  v_and_b32 v42, s67, v14
  v_and_b32 v43, s67, v15
  v_and_b32 v44, s67, v16
  v_and_b32 v45, s67, v17
  s_nop 1
  v_mfma_f32_16x16x32_bf16 v[64:67], v[42:45], v[128:131], v[64:67]
  v_mfma_f32_16x16x32_bf16 v[68:71], v[42:45], v[132:135], v[68:71]
  v_mfma_f32_16x16x32_bf16 v[72:75], v[42:45], v[136:139], v[72:75]
  v_mfma_f32_16x16x32_bf16 v[76:79], v[42:45], v[140:143], v[76:79]
  v_mfma_f32_16x16x32_bf16 v[80:83], v[42:45], v[144:147], v[80:83]
  v_mfma_f32_16x16x32_bf16 v[84:87], v[42:45], v[148:151], v[84:87]
  v_mfma_f32_16x16x32_bf16 v[88:91], v[42:45], v[152:155], v[88:91]
  v_mfma_f32_16x16x32_bf16 v[92:95], v[42:45], v[156:159], v[92:95]
attn_kernel_dt0:
  s_waitcnt vmcnt(5)
  s_cmp_ge_u32 s3, 2
  s_cbranch_scc1 attn_kernel_fx1
  s_sub_u32 s52, 15, s3
  v_cmp_eq_u32 vcc, s52, v1
  s_nop 1
  v_cndmask_b32 v48, 0, v50, vcc
  s_add_u32 s52, s52, 1
  v_cmp_eq_u32 vcc, s52, v1
  s_nop 1
  v_cndmask_b32 v48, v48, v51, vcc
  s_add_u32 s52, s71, 82176
  v_lshlrev_b32 v49, 2, v1
  v_add_u32 v49, s52, v49
  s_mov_b64 exec, 0xffff
  ds_write_b32 v49, v48
  s_mov_b64 exec, -1
attn_kernel_fx1:
  s_waitcnt vmcnt(0) lgkmcnt(0)
  s_barrier
  s_setprio 3
  s_add_u32 m0, s35, 0
  s_add_u32 s52, s50, 64512
  buffer_load_dwordx4 v2, s[8:11], s52 offen lds
  s_add_u32 m0, s35, 4096
  s_add_u32 s52, s50, 68608
  buffer_load_dwordx4 v2, s[8:11], s52 offen lds
  s_add_u32 m0, s35, 8192
  s_add_u32 s52, s50, 72704
  buffer_load_dwordx4 v2, s[8:11], s52 offen lds
  s_add_u32 m0, s35, 12288
  s_add_u32 s52, s50, 76800
  buffer_load_dwordx4 v2, s[8:11], s52 offen lds
  s_add_u32 m0, s35, 16384
  s_add_u32 s52, s50, 80896
  buffer_load_dwordx4 v2, s[8:11], s52 offen lds
  s_cmp_lg_u32 s3, 0
  s_cbranch_scc1 attn_kernel_kv5_3
  s_add_u32 m0, s35, 20480
  s_add_u32 s52, s50, 84992
  buffer_load_dwordx4 v2, s[8:11], s52 offen lds
attn_kernel_kv5_3:
  s_setprio 0
  s_setprio 3
  s_lshl_b32 s52, s3, 10
  s_add_u32 m0, s52, 124928
  s_add_u32 s52, s52, s51
  s_add_u32 s52, s52, 60416
  buffer_load_dwordx4 v2, s[8:11], s52 offen lds
  s_lshl_b32 s52, s3, 10
  s_add_u32 m0, s52, 129024
  s_add_u32 s52, s52, s51
  s_add_u32 s52, s52, 64512
  buffer_load_dwordx4 v2, s[8:11], s52 offen lds
  s_lshl_b32 s52, s3, 10
  s_add_u32 m0, s52, 133120
  s_add_u32 s52, s52, s51
  s_add_u32 s52, s52, 68608
  buffer_load_dwordx4 v2, s[8:11], s52 offen lds
  s_lshl_b32 s52, s3, 10
  s_add_u32 m0, s52, 137216
  s_add_u32 s52, s52, s51
  s_add_u32 s52, s52, 72704
  buffer_load_dwordx4 v2, s[8:11], s52 offen lds
  s_lshl_b32 s52, s3, 10
  s_add_u32 m0, s52, 141312
  s_add_u32 s52, s52, s51
  s_add_u32 s52, s52, 76800
  buffer_load_dwordx4 v2, s[8:11], s52 offen lds
  s_lshl_b32 s52, s3, 10
  s_add_u32 m0, s52, 145408
  s_add_u32 s52, s52, s51
  s_add_u32 s52, s52, 80896
  buffer_load_dwordx4 v2, s[8:11], s52 offen lds
  s_lshl_b32 s52, s3, 10
  s_add_u32 m0, s52, 149504
  s_add_u32 s52, s52, s51
  s_add_u32 s52, s52, 84992
  buffer_load_dwordx4 v2, s[8:11], s52 offen lds
  s_lshl_b32 s52, s3, 10
  s_add_u32 m0, s52, 153600
  s_add_u32 s52, s52, s51
  s_add_u32 s52, s52, 89088
  buffer_load_dwordx4 v2, s[8:11], s52 offen lds
  s_lshl_b32 s52, s3, 10
  s_add_u32 m0, s52, 157696
  s_add_u32 s52, s52, s51
  s_add_u32 s52, s52, 93184
  buffer_load_dwordx4 v2, s[8:11], s52 offen lds
  s_setprio 0
  s_setprio 3
  v_add_u32 v58, 64576, v7
  v_add_u32 v59, 64512, v13
  ds_read_b64 v[96:97], v58 offset:0
  ds_read_b64 v[98:99], v58 offset:8
  ds_read_b64 v[128:129], v59 offset:3584
  ds_read_b64 v[130:131], v59 offset:3592
  ds_read_b64 v[100:101], v58 offset:512
  ds_read_b64 v[102:103], v58 offset:520
  ds_read_b64 v[132:133], v59 offset:3072
  ds_read_b64 v[134:135], v59 offset:3080
  ds_read_b64 v[104:105], v58 offset:1024
  ds_read_b64 v[106:107], v58 offset:1032
  ds_read_b64 v[136:137], v59 offset:2560
  ds_read_b64 v[138:139], v59 offset:2568
  ds_read_b64 v[108:109], v58 offset:1536
  ds_read_b64 v[110:111], v58 offset:1544
  ds_read_b64 v[140:141], v59 offset:2048
  ds_read_b64 v[142:143], v59 offset:2056
  ds_read_b64 v[112:113], v58 offset:2048
  ds_read_b64 v[114:115], v58 offset:2056
  ds_read_b64 v[144:145], v59 offset:1536
  ds_read_b64 v[146:147], v59 offset:1544
  ds_read_b64 v[116:117], v58 offset:2560
  ds_read_b64 v[118:119], v58 offset:2568
  ds_read_b64 v[148:149], v59 offset:1024
  ds_read_b64 v[150:151], v59 offset:1032
  ds_read_b64 v[120:121], v58 offset:3072
  ds_read_b64 v[122:123], v58 offset:3080
  ds_read_b64 v[152:153], v59 offset:512
  ds_read_b64 v[154:155], v59 offset:520
  ds_read_b64 v[124:125], v58 offset:3584
  ds_read_b64 v[126:127], v58 offset:3592
  ds_read_b64 v[156:157], v59 offset:0
  ds_read_b64 v[158:159], v59 offset:8
  s_setprio 0
  s_waitcnt lgkmcnt(15)
  v_mfma_f32_16x16x32_bf16 v[64:67], v[96:99], v[128:131], v[64:67]
  s_waitcnt lgkmcnt(15)
  v_mfma_f32_16x16x32_bf16 v[68:71], v[100:103], v[128:131], v[68:71]
  s_waitcnt lgkmcnt(15)
  v_mfma_f32_16x16x32_bf16 v[68:71], v[96:99], v[132:135], v[68:71]
  v_mfma_f32_16x16x32_bf16 v[72:75], v[100:103], v[132:135], v[72:75]
  s_waitcnt lgkmcnt(15)
  v_mfma_f32_16x16x32_bf16 v[72:75], v[104:107], v[128:131], v[72:75]
  v_mfma_f32_16x16x32_bf16 v[76:79], v[104:107], v[132:135], v[76:79]
  s_waitcnt lgkmcnt(15)
  v_mfma_f32_16x16x32_bf16 v[72:75], v[96:99], v[136:139], v[72:75]
  v_mfma_f32_16x16x32_bf16 v[76:79], v[100:103], v[136:139], v[76:79]
  v_mfma_f32_16x16x32_bf16 v[80:83], v[104:107], v[136:139], v[80:83]
  s_waitcnt lgkmcnt(15)
  v_mfma_f32_16x16x32_bf16 v[76:79], v[108:111], v[128:131], v[76:79]
  v_mfma_f32_16x16x32_bf16 v[80:83], v[108:111], v[132:135], v[80:83]
  v_mfma_f32_16x16x32_bf16 v[84:87], v[108:111], v[136:139], v[84:87]
  s_waitcnt lgkmcnt(15)
  v_mfma_f32_16x16x32_bf16 v[76:79], v[96:99], v[140:143], v[76:79]
  v_mfma_f32_16x16x32_bf16 v[80:83], v[100:103], v[140:143], v[80:83]
  v_mfma_f32_16x16x32_bf16 v[84:87], v[104:107], v[140:143], v[84:87]
  v_mfma_f32_16x16x32_bf16 v[88:91], v[108:111], v[140:143], v[88:91]
  s_waitcnt lgkmcnt(14)
  v_mfma_f32_16x16x32_bf16 v[80:83], v[112:115], v[128:131], v[80:83]
  v_mfma_f32_16x16x32_bf16 v[84:87], v[112:115], v[132:135], v[84:87]
  v_mfma_f32_16x16x32_bf16 v[88:91], v[112:115], v[136:139], v[88:91]
  v_mfma_f32_16x16x32_bf16 v[92:95], v[112:115], v[140:143], v[92:95]
  s_waitcnt lgkmcnt(12)
  v_mfma_f32_16x16x32_bf16 v[80:83], v[96:99], v[144:147], v[80:83]
  v_mfma_f32_16x16x32_bf16 v[84:87], v[100:103], v[144:147], v[84:87]
  v_mfma_f32_16x16x32_bf16 v[88:91], v[104:107], v[144:147], v[88:91]
  v_mfma_f32_16x16x32_bf16 v[92:95], v[108:111], v[144:147], v[92:95]
  s_waitcnt lgkmcnt(10)
  v_mfma_f32_16x16x32_bf16 v[84:87], v[116:119], v[128:131], v[84:87]
  v_mfma_f32_16x16x32_bf16 v[88:91], v[116:119], v[132:135], v[88:91]
  v_mfma_f32_16x16x32_bf16 v[92:95], v[116:119], v[136:139], v[92:95]
  s_waitcnt lgkmcnt(8)
  v_mfma_f32_16x16x32_bf16 v[84:87], v[96:99], v[148:151], v[84:87]
  v_mfma_f32_16x16x32_bf16 v[88:91], v[100:103], v[148:151], v[88:91]
  v_mfma_f32_16x16x32_bf16 v[92:95], v[104:107], v[148:151], v[92:95]
  s_waitcnt lgkmcnt(6)
  v_mfma_f32_16x16x32_bf16 v[88:91], v[120:123], v[128:131], v[88:91]
  v_mfma_f32_16x16x32_bf16 v[92:95], v[120:123], v[132:135], v[92:95]
  s_waitcnt lgkmcnt(4)
  v_mfma_f32_16x16x32_bf16 v[88:91], v[96:99], v[152:155], v[88:91]
  v_mfma_f32_16x16x32_bf16 v[92:95], v[100:103], v[152:155], v[92:95]
  s_waitcnt lgkmcnt(2)
  v_mfma_f32_16x16x32_bf16 v[92:95], v[124:127], v[128:131], v[92:95]
  s_waitcnt lgkmcnt(0)
  v_mfma_f32_16x16x32_bf16 v[92:95], v[96:99], v[156:159], v[92:95]
  s_setprio 3
  s_cmp_lg_u32 s3, 0
  s_cbranch_scc1 attn_kernel_wp0_0
  v_add_u32 v58, 99840, v2
  v_mov_b32 v34, v64
  v_mov_b32 v35, v65
  v_mov_b32 v36, v66
  v_mov_b32 v37, v67
  v_mov_b32 v38, v68
  v_mov_b32 v39, v69
  v_mov_b32 v40, v70
  v_mov_b32 v41, v71
  ds_write_b128 v58, v[72:75] offset:10240
  ds_write_b128 v58, v[76:79] offset:11264
  ds_write_b128 v58, v[80:83] offset:14336
  ds_write_b128 v58, v[84:87] offset:15360
  ds_write_b128 v58, v[88:91] offset:18432
  ds_write_b128 v58, v[92:95] offset:19456
attn_kernel_wp0_0:
  s_cmp_lg_u32 s3, 1
  s_cbranch_scc1 attn_kernel_wp0_1
  v_add_u32 v58, 99840, v2
  ds_write_b128 v58, v[64:67] offset:0
  ds_write_b128 v58, v[68:71] offset:1024
  v_mov_b32 v34, v72
  v_mov_b32 v35, v73
  v_mov_b32 v36, v74
  v_mov_b32 v37, v75
  v_mov_b32 v38, v76
  v_mov_b32 v39, v77
  v_mov_b32 v40, v78
  v_mov_b32 v41, v79
  ds_write_b128 v58, v[80:83] offset:16384
  ds_write_b128 v58, v[84:87] offset:17408
  ds_write_b128 v58, v[88:91] offset:20480
  ds_write_b128 v58, v[92:95] offset:21504
attn_kernel_wp0_1:
  s_cmp_lg_u32 s3, 2
  s_cbranch_scc1 attn_kernel_wp0_2
  v_add_u32 v58, 99840, v2
  ds_write_b128 v58, v[64:67] offset:2048
  ds_write_b128 v58, v[68:71] offset:3072
  ds_write_b128 v58, v[72:75] offset:6144
  ds_write_b128 v58, v[76:79] offset:7168
  v_mov_b32 v34, v80
  v_mov_b32 v35, v81
  v_mov_b32 v36, v82
  v_mov_b32 v37, v83
  v_mov_b32 v38, v84
  v_mov_b32 v39, v85
  v_mov_b32 v40, v86
  v_mov_b32 v41, v87
  ds_write_b128 v58, v[88:91] offset:22528
  ds_write_b128 v58, v[92:95] offset:23552
attn_kernel_wp0_2:
  s_cmp_lg_u32 s3, 3
  s_cbranch_scc1 attn_kernel_wp0_3
  v_add_u32 v58, 99840, v2
  ds_write_b128 v58, v[64:67] offset:4096
  ds_write_b128 v58, v[68:71] offset:5120
  ds_write_b128 v58, v[72:75] offset:8192
  ds_write_b128 v58, v[76:79] offset:9216
  ds_write_b128 v58, v[80:83] offset:12288
  ds_write_b128 v58, v[84:87] offset:13312
  v_mov_b32 v34, v88
  v_mov_b32 v35, v89
  v_mov_b32 v36, v90
  v_mov_b32 v37, v91
  v_mov_b32 v38, v92
  v_mov_b32 v39, v93
  v_mov_b32 v40, v94
  v_mov_b32 v41, v95
attn_kernel_wp0_3:
  s_waitcnt lgkmcnt(0)
  s_setprio 0
  s_waitcnt vmcnt(0) lgkmcnt(0)
  s_barrier
  s_setprio 3
  s_add_u32 m0, s35, 21504
  s_add_u32 s52, s50, 86016
  buffer_load_dwordx4 v2, s[8:11], s52 offen lds
  s_add_u32 m0, s35, 25600
  s_add_u32 s52, s50, 90112
  buffer_load_dwordx4 v2, s[8:11], s52 offen lds
  s_add_u32 m0, s35, 29696
  s_add_u32 s52, s50, 94208
  buffer_load_dwordx4 v2, s[8:11], s52 offen lds
  s_add_u32 m0, s35, 33792
  s_add_u32 s52, s50, 98304
  buffer_load_dwordx4 v2, s[8:11], s52 offen lds
  s_add_u32 m0, s35, 37888
  s_add_u32 s52, s50, 102400
  buffer_load_dwordx4 v2, s[8:11], s52 offen lds
  s_cmp_lg_u32 s3, 0
  s_cbranch_scc1 attn_kernel_kv5_4
  s_add_u32 m0, s35, 41984
  s_add_u32 s52, s50, 106496
  buffer_load_dwordx4 v2, s[8:11], s52 offen lds
attn_kernel_kv5_4:
  s_setprio 0
  s_setprio 3
  s_lshl_b32 s52, s66, 12
  v_mov_b32 v48, 0
  buffer_load_dwordx2 v[54:55], v48, s[12:15], s52 offen
  s_mul_i32 s53, s66, 4352
  s_add_u32 s53, s53, 8126464
  s_add_u32 s16, s4, s53
  s_addc_u32 s17, s5, 0
  s_and_b32 s17, s17, 0xffff
  s_mov_b32 s18, 4112
  s_mov_b32 s19, 0x00020000
  s_add_u32 s53, s71, 64512
  s_cmp_lt_u32 s3, 2
  s_cbranch_scc1 attn_kernel_ci2hu_ha
  s_add_u32 m0, s53, 0
  s_mov_b32 s54, 0
  buffer_load_dwordx4 v3, s[16:19], s54 offen lds
  s_add_u32 m0, s53, 1024
  s_mov_b32 s54, 1024
  buffer_load_dwordx4 v3, s[16:19], s54 offen lds
  s_add_u32 m0, s53, 2048
  s_mov_b32 s54, 2048
  buffer_load_dwordx4 v3, s[16:19], s54 offen lds
  s_add_u32 m0, s53, 3072
  s_mov_b32 s54, 3072
  buffer_load_dwordx4 v3, s[16:19], s54 offen lds
  s_mov_b64 exec, s[74:75]
  s_add_u32 m0, s53, 4096
  s_mov_b32 s54, 4096
  buffer_load_dwordx4 v3, s[16:19], s54 offen lds
  s_branch attn_kernel_ci2hu_done
attn_kernel_ci2hu_ha:
  s_mov_b64 exec, s[72:73]
  s_add_u32 m0, s53, 0
  s_add_u32 s54, s52, 0
  buffer_load_dwordx4 v3, s[12:15], s54 offen lds
  s_mov_b64 exec, -1
  s_add_u32 m0, s53, 1024
  s_add_u32 s54, s52, 960
  buffer_load_dwordx4 v10, s[12:15], s54 offen lds
  s_add_u32 m0, s53, 2048
  s_add_u32 s54, s52, 1984
  buffer_load_dwordx4 v10, s[12:15], s54 offen lds
  s_add_u32 m0, s53, 3072
  s_add_u32 s54, s52, 3008
  buffer_load_dwordx4 v10, s[12:15], s54 offen lds
  s_mov_b64 exec, s[74:75]
  s_add_u32 m0, s53, 4096
  s_add_u32 s54, s52, 4032
  buffer_load_dwordx4 v10, s[12:15], s54 offen lds
attn_kernel_ci2hu_done:
  s_mov_b64 exec, -1
  s_setprio 0
  s_setprio 3
  s_mul_i32 s52, s3, 6144
  s_add_u32 s52, s52, 99840
  v_add_u32 v58, s52, v2
  ds_read_b128 v[18:21], v58 offset:0
  ds_read_b128 v[22:25], v58 offset:2048
  ds_read_b128 v[26:29], v58 offset:4096
  s_waitcnt lgkmcnt(0)
  v_add_f32 v18, v18, v22
  v_add_f32 v34, v34, v26
  v_add_f32 v18, v18, v34
  v_add_f32 v19, v19, v23
  v_add_f32 v35, v35, v27
  v_add_f32 v19, v19, v35
  v_add_f32 v20, v20, v24
  v_add_f32 v36, v36, v28
  v_add_f32 v20, v20, v36
  v_add_f32 v21, v21, v25
  v_add_f32 v37, v37, v29
  v_add_f32 v21, v21, v37
  v_cvt_pk_bf16_f32 v30, v18, v19
  v_cvt_pk_bf16_f32 v31, v20, v21
  s_lshl_b32 s53, s3, 1
  s_lshl_b32 s53, s53, 9
  s_lshl_b32 s54, s64, 12
  s_add_u32 s53, s53, s54
  s_add_u32 s53, s53, 13549568
  v_lshlrev_b32 v59, 3, v1
  buffer_store_dwordx2 v[30:31], v59, s[8:11], s53 offen sc1
  ds_read_b128 v[18:21], v58 offset:1024
  ds_read_b128 v[22:25], v58 offset:3072
  ds_read_b128 v[26:29], v58 offset:5120
  s_waitcnt lgkmcnt(0)
  v_add_f32 v18, v18, v22
  v_add_f32 v38, v38, v26
  v_add_f32 v18, v18, v38
  v_add_f32 v19, v19, v23
  v_add_f32 v39, v39, v27
  v_add_f32 v19, v19, v39
  v_add_f32 v20, v20, v24
  v_add_f32 v40, v40, v28
  v_add_f32 v20, v20, v40
  v_add_f32 v21, v21, v25
  v_add_f32 v41, v41, v29
  v_add_f32 v21, v21, v41
  v_cvt_pk_bf16_f32 v32, v18, v19
  v_cvt_pk_bf16_f32 v33, v20, v21
  s_lshl_b32 s53, s3, 1
  s_add_u32 s53, s53, 1
  s_lshl_b32 s53, s53, 9
  s_lshl_b32 s54, s64, 12
  s_add_u32 s53, s53, s54
  s_add_u32 s53, s53, 13549568
  v_lshlrev_b32 v59, 3, v1
  buffer_store_dwordx2 v[32:33], v59, s[8:11], s53 offen sc1
  s_setprio 0
  s_setprio 3
  v_add_u32 v58, 82176, v7
  v_add_u32 v59, 82176, v12
  ds_read_b64 v[96:97], v58 offset:0
  ds_read_b64 v[98:99], v58 offset:8
  ds_read_b64 v[128:129], v59 offset:3584
  ds_read_b64 v[130:131], v59 offset:3592
  ds_read_b64 v[100:101], v58 offset:512
  ds_read_b64 v[102:103], v58 offset:520
  ds_read_b64 v[132:133], v59 offset:3072
  ds_read_b64 v[134:135], v59 offset:3080
  ds_read_b64 v[104:105], v58 offset:1024
  ds_read_b64 v[106:107], v58 offset:1032
  ds_read_b64 v[136:137], v59 offset:2560
  ds_read_b64 v[138:139], v59 offset:2568
  ds_read_b64 v[108:109], v58 offset:1536
  ds_read_b64 v[110:111], v58 offset:1544
  ds_read_b64 v[140:141], v59 offset:2048
  ds_read_b64 v[142:143], v59 offset:2056
  ds_read_b64 v[112:113], v58 offset:2048
  ds_read_b64 v[114:115], v58 offset:2056
  ds_read_b64 v[144:145], v59 offset:1536
  ds_read_b64 v[146:147], v59 offset:1544
  ds_read_b64 v[116:117], v58 offset:2560
  ds_read_b64 v[118:119], v58 offset:2568
  ds_read_b64 v[148:149], v59 offset:1024
  ds_read_b64 v[150:151], v59 offset:1032
  ds_read_b64 v[120:121], v58 offset:3072
  ds_read_b64 v[122:123], v58 offset:3080
  ds_read_b64 v[152:153], v59 offset:512
  ds_read_b64 v[154:155], v59 offset:520
  ds_read_b64 v[124:125], v58 offset:3584
  ds_read_b64 v[126:127], v58 offset:3592
  ds_read_b64 v[156:157], v59 offset:0
  ds_read_b64 v[158:159], v59 offset:8
  s_setprio 0
  s_waitcnt lgkmcnt(15)
  v_mfma_f32_16x16x32_bf16 v[64:67], v[96:99], v[128:131], 0
  s_waitcnt lgkmcnt(15)
  v_mfma_f32_16x16x32_bf16 v[68:71], v[100:103], v[128:131], 0
  s_waitcnt lgkmcnt(15)
  v_mfma_f32_16x16x32_bf16 v[68:71], v[96:99], v[132:135], v[68:71]
  v_mfma_f32_16x16x32_bf16 v[72:75], v[100:103], v[132:135], 0
  s_waitcnt lgkmcnt(15)
  v_mfma_f32_16x16x32_bf16 v[72:75], v[104:107], v[128:131], v[72:75]
  v_mfma_f32_16x16x32_bf16 v[76:79], v[104:107], v[132:135], 0
  s_waitcnt lgkmcnt(15)
  v_mfma_f32_16x16x32_bf16 v[72:75], v[96:99], v[136:139], v[72:75]
  v_mfma_f32_16x16x32_bf16 v[76:79], v[100:103], v[136:139], v[76:79]
  v_mfma_f32_16x16x32_bf16 v[80:83], v[104:107], v[136:139], 0
  s_waitcnt lgkmcnt(15)
  v_mfma_f32_16x16x32_bf16 v[76:79], v[108:111], v[128:131], v[76:79]
  v_mfma_f32_16x16x32_bf16 v[80:83], v[108:111], v[132:135], v[80:83]
  v_mfma_f32_16x16x32_bf16 v[84:87], v[108:111], v[136:139], 0
  s_waitcnt lgkmcnt(15)
  v_mfma_f32_16x16x32_bf16 v[76:79], v[96:99], v[140:143], v[76:79]
  v_mfma_f32_16x16x32_bf16 v[80:83], v[100:103], v[140:143], v[80:83]
  v_mfma_f32_16x16x32_bf16 v[84:87], v[104:107], v[140:143], v[84:87]
  v_mfma_f32_16x16x32_bf16 v[88:91], v[108:111], v[140:143], 0
  s_waitcnt lgkmcnt(14)
  v_mfma_f32_16x16x32_bf16 v[80:83], v[112:115], v[128:131], v[80:83]
  v_mfma_f32_16x16x32_bf16 v[84:87], v[112:115], v[132:135], v[84:87]
  v_mfma_f32_16x16x32_bf16 v[88:91], v[112:115], v[136:139], v[88:91]
  v_mfma_f32_16x16x32_bf16 v[92:95], v[112:115], v[140:143], 0
  s_waitcnt lgkmcnt(12)
  v_mfma_f32_16x16x32_bf16 v[80:83], v[96:99], v[144:147], v[80:83]
  v_mfma_f32_16x16x32_bf16 v[84:87], v[100:103], v[144:147], v[84:87]
  v_mfma_f32_16x16x32_bf16 v[88:91], v[104:107], v[144:147], v[88:91]
  v_mfma_f32_16x16x32_bf16 v[92:95], v[108:111], v[144:147], v[92:95]
  s_waitcnt lgkmcnt(10)
  v_mfma_f32_16x16x32_bf16 v[84:87], v[116:119], v[128:131], v[84:87]
  v_mfma_f32_16x16x32_bf16 v[88:91], v[116:119], v[132:135], v[88:91]
  v_mfma_f32_16x16x32_bf16 v[92:95], v[116:119], v[136:139], v[92:95]
  s_waitcnt lgkmcnt(8)
  v_mfma_f32_16x16x32_bf16 v[84:87], v[96:99], v[148:151], v[84:87]
  v_mfma_f32_16x16x32_bf16 v[88:91], v[100:103], v[148:151], v[88:91]
  v_mfma_f32_16x16x32_bf16 v[92:95], v[104:107], v[148:151], v[92:95]
  s_waitcnt lgkmcnt(6)
  v_mfma_f32_16x16x32_bf16 v[88:91], v[120:123], v[128:131], v[88:91]
  v_mfma_f32_16x16x32_bf16 v[92:95], v[120:123], v[132:135], v[92:95]
  s_waitcnt lgkmcnt(4)
  v_mfma_f32_16x16x32_bf16 v[88:91], v[96:99], v[152:155], v[88:91]
  v_mfma_f32_16x16x32_bf16 v[92:95], v[100:103], v[152:155], v[92:95]
  s_waitcnt lgkmcnt(2)
  v_mfma_f32_16x16x32_bf16 v[92:95], v[124:127], v[128:131], v[92:95]
  s_waitcnt lgkmcnt(0)
  v_mfma_f32_16x16x32_bf16 v[92:95], v[96:99], v[156:159], v[92:95]
  s_cmp_lg_u32 s3, 0
  s_cbranch_scc1 attn_kernel_dt1
  v_and_b32 v42, s68, v14
  v_and_b32 v43, s68, v15
  v_and_b32 v44, s68, v16
  v_and_b32 v45, s68, v17
  s_nop 1
  v_mfma_f32_16x16x32_bf16 v[64:67], v[42:45], v[128:131], v[64:67]
  v_mfma_f32_16x16x32_bf16 v[68:71], v[42:45], v[132:135], v[68:71]
  v_mfma_f32_16x16x32_bf16 v[72:75], v[42:45], v[136:139], v[72:75]
  v_mfma_f32_16x16x32_bf16 v[76:79], v[42:45], v[140:143], v[76:79]
  v_mfma_f32_16x16x32_bf16 v[80:83], v[42:45], v[144:147], v[80:83]
  v_mfma_f32_16x16x32_bf16 v[84:87], v[42:45], v[148:151], v[84:87]
  v_mfma_f32_16x16x32_bf16 v[88:91], v[42:45], v[152:155], v[88:91]
  v_mfma_f32_16x16x32_bf16 v[92:95], v[42:45], v[156:159], v[92:95]
attn_kernel_dt1:
  s_waitcnt vmcnt(0) lgkmcnt(0)
  s_barrier
  s_setprio 3
  s_add_u32 m0, s35, 43008
  s_add_u32 s52, s50, 107520
  buffer_load_dwordx4 v2, s[8:11], s52 offen lds
  s_add_u32 m0, s35, 47104
  s_add_u32 s52, s50, 111616
  buffer_load_dwordx4 v2, s[8:11], s52 offen lds
  s_add_u32 m0, s35, 51200
  s_add_u32 s52, s50, 115712
  buffer_load_dwordx4 v2, s[8:11], s52 offen lds
  s_add_u32 m0, s35, 55296
  s_add_u32 s52, s50, 119808
  buffer_load_dwordx4 v2, s[8:11], s52 offen lds
  s_add_u32 m0, s35, 59392
  s_add_u32 s52, s50, 123904
  buffer_load_dwordx4 v2, s[8:11], s52 offen lds
  s_cmp_lg_u32 s3, 0
  s_cbranch_scc1 attn_kernel_kv5_5
  s_add_u32 m0, s35, 63488
  s_add_u32 s52, s50, 128000
  buffer_load_dwordx4 v2, s[8:11], s52 offen lds
attn_kernel_kv5_5:
  s_setprio 0
  s_setprio 3
  v_add_u32 v58, 82240, v7
  v_add_u32 v59, 82176, v13
  ds_read_b64 v[96:97], v58 offset:0
  ds_read_b64 v[98:99], v58 offset:8
  ds_read_b64 v[128:129], v59 offset:3584
  ds_read_b64 v[130:131], v59 offset:3592
  ds_read_b64 v[100:101], v58 offset:512
  ds_read_b64 v[102:103], v58 offset:520
  ds_read_b64 v[132:133], v59 offset:3072
  ds_read_b64 v[134:135], v59 offset:3080
  ds_read_b64 v[104:105], v58 offset:1024
  ds_read_b64 v[106:107], v58 offset:1032
  ds_read_b64 v[136:137], v59 offset:2560
  ds_read_b64 v[138:139], v59 offset:2568
  ds_read_b64 v[108:109], v58 offset:1536
  ds_read_b64 v[110:111], v58 offset:1544
  ds_read_b64 v[140:141], v59 offset:2048
  ds_read_b64 v[142:143], v59 offset:2056
  ds_read_b64 v[112:113], v58 offset:2048
  ds_read_b64 v[114:115], v58 offset:2056
  ds_read_b64 v[144:145], v59 offset:1536
  ds_read_b64 v[146:147], v59 offset:1544
  ds_read_b64 v[116:117], v58 offset:2560
  ds_read_b64 v[118:119], v58 offset:2568
  ds_read_b64 v[148:149], v59 offset:1024
  ds_read_b64 v[150:151], v59 offset:1032
  ds_read_b64 v[120:121], v58 offset:3072
  ds_read_b64 v[122:123], v58 offset:3080
  ds_read_b64 v[152:153], v59 offset:512
  ds_read_b64 v[154:155], v59 offset:520
  ds_read_b64 v[124:125], v58 offset:3584
  ds_read_b64 v[126:127], v58 offset:3592
  ds_read_b64 v[156:157], v59 offset:0
  ds_read_b64 v[158:159], v59 offset:8
  s_setprio 0
  s_waitcnt lgkmcnt(15)
  v_mfma_f32_16x16x32_bf16 v[64:67], v[96:99], v[128:131], v[64:67]
  s_waitcnt lgkmcnt(15)
  v_mfma_f32_16x16x32_bf16 v[68:71], v[100:103], v[128:131], v[68:71]
  s_waitcnt lgkmcnt(15)
  v_mfma_f32_16x16x32_bf16 v[68:71], v[96:99], v[132:135], v[68:71]
  v_mfma_f32_16x16x32_bf16 v[72:75], v[100:103], v[132:135], v[72:75]
  s_waitcnt lgkmcnt(15)
  v_mfma_f32_16x16x32_bf16 v[72:75], v[104:107], v[128:131], v[72:75]
  v_mfma_f32_16x16x32_bf16 v[76:79], v[104:107], v[132:135], v[76:79]
  s_waitcnt lgkmcnt(15)
  v_mfma_f32_16x16x32_bf16 v[72:75], v[96:99], v[136:139], v[72:75]
  v_mfma_f32_16x16x32_bf16 v[76:79], v[100:103], v[136:139], v[76:79]
  v_mfma_f32_16x16x32_bf16 v[80:83], v[104:107], v[136:139], v[80:83]
  s_waitcnt lgkmcnt(15)
  v_mfma_f32_16x16x32_bf16 v[76:79], v[108:111], v[128:131], v[76:79]
  v_mfma_f32_16x16x32_bf16 v[80:83], v[108:111], v[132:135], v[80:83]
  v_mfma_f32_16x16x32_bf16 v[84:87], v[108:111], v[136:139], v[84:87]
  s_waitcnt lgkmcnt(15)
  v_mfma_f32_16x16x32_bf16 v[76:79], v[96:99], v[140:143], v[76:79]
  v_mfma_f32_16x16x32_bf16 v[80:83], v[100:103], v[140:143], v[80:83]
  v_mfma_f32_16x16x32_bf16 v[84:87], v[104:107], v[140:143], v[84:87]
  v_mfma_f32_16x16x32_bf16 v[88:91], v[108:111], v[140:143], v[88:91]
  s_waitcnt lgkmcnt(14)
  v_mfma_f32_16x16x32_bf16 v[80:83], v[112:115], v[128:131], v[80:83]
  v_mfma_f32_16x16x32_bf16 v[84:87], v[112:115], v[132:135], v[84:87]
  v_mfma_f32_16x16x32_bf16 v[88:91], v[112:115], v[136:139], v[88:91]
  v_mfma_f32_16x16x32_bf16 v[92:95], v[112:115], v[140:143], v[92:95]
  s_waitcnt lgkmcnt(12)
  v_mfma_f32_16x16x32_bf16 v[80:83], v[96:99], v[144:147], v[80:83]
  v_mfma_f32_16x16x32_bf16 v[84:87], v[100:103], v[144:147], v[84:87]
  v_mfma_f32_16x16x32_bf16 v[88:91], v[104:107], v[144:147], v[88:91]
  v_mfma_f32_16x16x32_bf16 v[92:95], v[108:111], v[144:147], v[92:95]
  s_waitcnt lgkmcnt(10)
  v_mfma_f32_16x16x32_bf16 v[84:87], v[116:119], v[128:131], v[84:87]
  v_mfma_f32_16x16x32_bf16 v[88:91], v[116:119], v[132:135], v[88:91]
  v_mfma_f32_16x16x32_bf16 v[92:95], v[116:119], v[136:139], v[92:95]
  s_waitcnt lgkmcnt(8)
  v_mfma_f32_16x16x32_bf16 v[84:87], v[96:99], v[148:151], v[84:87]
  v_mfma_f32_16x16x32_bf16 v[88:91], v[100:103], v[148:151], v[88:91]
  v_mfma_f32_16x16x32_bf16 v[92:95], v[104:107], v[148:151], v[92:95]
  s_waitcnt lgkmcnt(6)
  v_mfma_f32_16x16x32_bf16 v[88:91], v[120:123], v[128:131], v[88:91]
  v_mfma_f32_16x16x32_bf16 v[92:95], v[120:123], v[132:135], v[92:95]
  s_waitcnt lgkmcnt(4)
  v_mfma_f32_16x16x32_bf16 v[88:91], v[96:99], v[152:155], v[88:91]
  v_mfma_f32_16x16x32_bf16 v[92:95], v[100:103], v[152:155], v[92:95]
  s_waitcnt lgkmcnt(2)
  v_mfma_f32_16x16x32_bf16 v[92:95], v[124:127], v[128:131], v[92:95]
  s_waitcnt lgkmcnt(0)
  v_mfma_f32_16x16x32_bf16 v[92:95], v[96:99], v[156:159], v[92:95]
  s_setprio 3
  s_cmp_lg_u32 s3, 0
  s_cbranch_scc1 attn_kernel_wp1_0
  v_add_u32 v58, 99840, v2
  v_mov_b32 v34, v64
  v_mov_b32 v35, v65
  v_mov_b32 v36, v66
  v_mov_b32 v37, v67
  v_mov_b32 v38, v68
  v_mov_b32 v39, v69
  v_mov_b32 v40, v70
  v_mov_b32 v41, v71
  ds_write_b128 v58, v[72:75] offset:10240
  ds_write_b128 v58, v[76:79] offset:11264
  ds_write_b128 v58, v[80:83] offset:14336
  ds_write_b128 v58, v[84:87] offset:15360
  ds_write_b128 v58, v[88:91] offset:18432
  ds_write_b128 v58, v[92:95] offset:19456
attn_kernel_wp1_0:
  s_cmp_lg_u32 s3, 1
  s_cbranch_scc1 attn_kernel_wp1_1
  v_add_u32 v58, 99840, v2
  ds_write_b128 v58, v[64:67] offset:0
  ds_write_b128 v58, v[68:71] offset:1024
  v_mov_b32 v34, v72
  v_mov_b32 v35, v73
  v_mov_b32 v36, v74
  v_mov_b32 v37, v75
  v_mov_b32 v38, v76
  v_mov_b32 v39, v77
  v_mov_b32 v40, v78
  v_mov_b32 v41, v79
  ds_write_b128 v58, v[80:83] offset:16384
  ds_write_b128 v58, v[84:87] offset:17408
  ds_write_b128 v58, v[88:91] offset:20480
  ds_write_b128 v58, v[92:95] offset:21504
attn_kernel_wp1_1:
  s_cmp_lg_u32 s3, 2
  s_cbranch_scc1 attn_kernel_wp1_2
  v_add_u32 v58, 99840, v2
  ds_write_b128 v58, v[64:67] offset:2048
  ds_write_b128 v58, v[68:71] offset:3072
  ds_write_b128 v58, v[72:75] offset:6144
  ds_write_b128 v58, v[76:79] offset:7168
  v_mov_b32 v34, v80
  v_mov_b32 v35, v81
  v_mov_b32 v36, v82
  v_mov_b32 v37, v83
  v_mov_b32 v38, v84
  v_mov_b32 v39, v85
  v_mov_b32 v40, v86
  v_mov_b32 v41, v87
  ds_write_b128 v58, v[88:91] offset:22528
  ds_write_b128 v58, v[92:95] offset:23552
attn_kernel_wp1_2:
  s_cmp_lg_u32 s3, 3
  s_cbranch_scc1 attn_kernel_wp1_3
  v_add_u32 v58, 99840, v2
  ds_write_b128 v58, v[64:67] offset:4096
  ds_write_b128 v58, v[68:71] offset:5120
  ds_write_b128 v58, v[72:75] offset:8192
  ds_write_b128 v58, v[76:79] offset:9216
  ds_write_b128 v58, v[80:83] offset:12288
  ds_write_b128 v58, v[84:87] offset:13312
  v_mov_b32 v34, v88
  v_mov_b32 v35, v89
  v_mov_b32 v36, v90
  v_mov_b32 v37, v91
  v_mov_b32 v38, v92
  v_mov_b32 v39, v93
  v_mov_b32 v40, v94
  v_mov_b32 v41, v95
attn_kernel_wp1_3:
  s_waitcnt lgkmcnt(0)
  s_setprio 0
  s_cmp_ge_u32 s3, 2
  s_cbranch_scc1 attn_kernel_fx2
  s_sub_u32 s52, 15, s3
  v_cmp_eq_u32 vcc, s52, v1
  s_nop 1
  v_cndmask_b32 v48, 0, v54, vcc
  s_add_u32 s52, s52, 1
  v_cmp_eq_u32 vcc, s52, v1
  s_nop 1
  v_cndmask_b32 v48, v48, v55, vcc
  s_add_u32 s52, s71, 64512
  v_lshlrev_b32 v49, 2, v1
  v_add_u32 v49, s52, v49
  s_mov_b64 exec, 0xffff
  ds_write_b32 v49, v48
  s_mov_b64 exec, -1
attn_kernel_fx2:
  s_waitcnt vmcnt(0) lgkmcnt(0)
  s_barrier
  s_setprio 3
  s_add_u32 m0, s35, 0
  s_add_u32 s52, s50, 129024
  buffer_load_dwordx4 v2, s[8:11], s52 offen lds
  s_add_u32 m0, s35, 4096
  s_add_u32 s52, s50, 133120
  buffer_load_dwordx4 v2, s[8:11], s52 offen lds
  s_add_u32 m0, s35, 8192
  s_add_u32 s52, s50, 137216
  buffer_load_dwordx4 v2, s[8:11], s52 offen lds
  s_add_u32 m0, s35, 12288
  s_add_u32 s52, s50, 141312
  buffer_load_dwordx4 v2, s[8:11], s52 offen lds
  s_add_u32 m0, s35, 16384
  s_add_u32 s52, s50, 145408
  buffer_load_dwordx4 v2, s[8:11], s52 offen lds
  s_cmp_lg_u32 s3, 0
  s_cbranch_scc1 attn_kernel_kv5_6
  s_add_u32 m0, s35, 20480
  s_add_u32 s52, s50, 149504
  buffer_load_dwordx4 v2, s[8:11], s52 offen lds
attn_kernel_kv5_6:
  s_setprio 0
  s_setprio 3
  s_mul_i32 s52, s3, 6144
  s_add_u32 s52, s52, 99840
  v_add_u32 v58, s52, v2
  ds_read_b128 v[18:21], v58 offset:0
  ds_read_b128 v[22:25], v58 offset:2048
  ds_read_b128 v[26:29], v58 offset:4096
  s_waitcnt lgkmcnt(0)
  v_add_f32 v18, v18, v22
  v_add_f32 v34, v34, v26
  v_add_f32 v18, v18, v34
  v_add_f32 v19, v19, v23
  v_add_f32 v35, v35, v27
  v_add_f32 v19, v19, v35
  v_add_f32 v20, v20, v24
  v_add_f32 v36, v36, v28
  v_add_f32 v20, v20, v36
  v_add_f32 v21, v21, v25
  v_add_f32 v37, v37, v29
  v_add_f32 v21, v21, v37
  v_cvt_pk_bf16_f32 v30, v18, v19
  v_cvt_pk_bf16_f32 v31, v20, v21
  s_lshl_b32 s53, s3, 1
  s_lshl_b32 s53, s53, 9
  s_lshl_b32 s54, s65, 12
  s_add_u32 s53, s53, s54
  s_add_u32 s53, s53, 13549568
  v_lshlrev_b32 v59, 3, v1
  buffer_store_dwordx2 v[30:31], v59, s[8:11], s53 offen sc1
  ds_read_b128 v[18:21], v58 offset:1024
  ds_read_b128 v[22:25], v58 offset:3072
  ds_read_b128 v[26:29], v58 offset:5120
  s_waitcnt lgkmcnt(0)
  v_add_f32 v18, v18, v22
  v_add_f32 v38, v38, v26
  v_add_f32 v18, v18, v38
  v_add_f32 v19, v19, v23
  v_add_f32 v39, v39, v27
  v_add_f32 v19, v19, v39
  v_add_f32 v20, v20, v24
  v_add_f32 v40, v40, v28
  v_add_f32 v20, v20, v40
  v_add_f32 v21, v21, v25
  v_add_f32 v41, v41, v29
  v_add_f32 v21, v21, v41
  v_cvt_pk_bf16_f32 v32, v18, v19
  v_cvt_pk_bf16_f32 v33, v20, v21
  s_lshl_b32 s53, s3, 1
  s_add_u32 s53, s53, 1
  s_lshl_b32 s53, s53, 9
  s_lshl_b32 s54, s65, 12
  s_add_u32 s53, s53, s54
  s_add_u32 s53, s53, 13549568
  v_lshlrev_b32 v59, 3, v1
  buffer_store_dwordx2 v[32:33], v59, s[8:11], s53 offen sc1
  s_setprio 0
  s_and_b32 s52, s2, 1
  s_cmp_eq_u32 s52, 1
  s_cbranch_scc1 attn_kernel_po_1
  s_setprio 3
  v_add_u32 v58, 64512, v7
  v_add_u32 v59, 64512, v12
  ds_read_b64 v[96:97], v58 offset:0
  ds_read_b64 v[98:99], v58 offset:8
  ds_read_b64 v[128:129], v59 offset:3584
  ds_read_b64 v[130:131], v59 offset:3592
  ds_read_b64 v[100:101], v58 offset:512
  ds_read_b64 v[102:103], v58 offset:520
  ds_read_b64 v[132:133], v59 offset:3072
  ds_read_b64 v[134:135], v59 offset:3080
  ds_read_b64 v[104:105], v58 offset:1024
  ds_read_b64 v[106:107], v58 offset:1032
  ds_read_b64 v[136:137], v59 offset:2560
  ds_read_b64 v[138:139], v59 offset:2568
  ds_read_b64 v[108:109], v58 offset:1536
  ds_read_b64 v[110:111], v58 offset:1544
  ds_read_b64 v[140:141], v59 offset:2048
  ds_read_b64 v[142:143], v59 offset:2056
  ds_read_b64 v[112:113], v58 offset:2048
  ds_read_b64 v[114:115], v58 offset:2056
  ds_read_b64 v[144:145], v59 offset:1536
  ds_read_b64 v[146:147], v59 offset:1544
  ds_read_b64 v[116:117], v58 offset:2560
  ds_read_b64 v[118:119], v58 offset:2568
  ds_read_b64 v[148:149], v59 offset:1024
  ds_read_b64 v[150:151], v59 offset:1032
  ds_read_b64 v[120:121], v58 offset:3072
  ds_read_b64 v[122:123], v58 offset:3080
  ds_read_b64 v[152:153], v59 offset:512
  ds_read_b64 v[154:155], v59 offset:520
  ds_read_b64 v[124:125], v58 offset:3584
  ds_read_b64 v[126:127], v58 offset:3592
  ds_read_b64 v[156:157], v59 offset:0
  ds_read_b64 v[158:159], v59 offset:8
  s_setprio 0
  s_waitcnt lgkmcnt(15)
  v_mfma_f32_16x16x32_bf16 v[64:67], v[96:99], v[128:131], 0
  s_waitcnt lgkmcnt(15)
  v_mfma_f32_16x16x32_bf16 v[76:79], v[104:107], v[132:135], 0
  s_waitcnt lgkmcnt(15)
  v_mfma_f32_16x16x32_bf16 v[76:79], v[100:103], v[136:139], v[76:79]
  v_mfma_f32_16x16x32_bf16 v[80:83], v[104:107], v[136:139], 0
  s_waitcnt lgkmcnt(15)
  v_mfma_f32_16x16x32_bf16 v[76:79], v[108:111], v[128:131], v[76:79]
  v_mfma_f32_16x16x32_bf16 v[80:83], v[108:111], v[132:135], v[80:83]
  s_waitcnt lgkmcnt(15)
  v_mfma_f32_16x16x32_bf16 v[76:79], v[96:99], v[140:143], v[76:79]
  v_mfma_f32_16x16x32_bf16 v[80:83], v[100:103], v[140:143], v[80:83]
  s_waitcnt lgkmcnt(14)
  v_mfma_f32_16x16x32_bf16 v[80:83], v[112:115], v[128:131], v[80:83]
  v_mfma_f32_16x16x32_bf16 v[92:95], v[112:115], v[140:143], 0
  s_waitcnt lgkmcnt(12)
  v_mfma_f32_16x16x32_bf16 v[80:83], v[96:99], v[144:147], v[80:83]
  v_mfma_f32_16x16x32_bf16 v[92:95], v[108:111], v[144:147], v[92:95]
  s_waitcnt lgkmcnt(10)
  v_mfma_f32_16x16x32_bf16 v[92:95], v[116:119], v[136:139], v[92:95]
  s_waitcnt lgkmcnt(8)
  v_mfma_f32_16x16x32_bf16 v[92:95], v[104:107], v[148:151], v[92:95]
  s_waitcnt lgkmcnt(6)
  v_mfma_f32_16x16x32_bf16 v[92:95], v[120:123], v[132:135], v[92:95]
  s_waitcnt lgkmcnt(4)
  v_mfma_f32_16x16x32_bf16 v[92:95], v[100:103], v[152:155], v[92:95]
  s_waitcnt lgkmcnt(2)
  v_mfma_f32_16x16x32_bf16 v[92:95], v[124:127], v[128:131], v[92:95]
  s_waitcnt lgkmcnt(0)
  v_mfma_f32_16x16x32_bf16 v[92:95], v[96:99], v[156:159], v[92:95]
  s_cmp_lg_u32 s3, 0
  s_cbranch_scc1 attn_kernel_dt2e
  v_and_b32 v42, s69, v14
  v_and_b32 v43, s69, v15
  v_and_b32 v44, s69, v16
  v_and_b32 v45, s69, v17
  s_nop 1
  v_mfma_f32_16x16x32_bf16 v[64:67], v[42:45], v[128:131], v[64:67]
  v_mfma_f32_16x16x32_bf16 v[76:79], v[42:45], v[140:143], v[76:79]
  v_mfma_f32_16x16x32_bf16 v[80:83], v[42:45], v[144:147], v[80:83]
  v_mfma_f32_16x16x32_bf16 v[92:95], v[42:45], v[156:159], v[92:95]
attn_kernel_dt2e:
  s_setprio 3
  v_add_u32 v58, 64576, v7
  v_add_u32 v59, 64512, v13
  ds_read_b64 v[96:97], v58 offset:0
  ds_read_b64 v[98:99], v58 offset:8
  ds_read_b64 v[128:129], v59 offset:3584
  ds_read_b64 v[130:131], v59 offset:3592
  ds_read_b64 v[100:101], v58 offset:512
  ds_read_b64 v[102:103], v58 offset:520
  ds_read_b64 v[132:133], v59 offset:3072
  ds_read_b64 v[134:135], v59 offset:3080
  ds_read_b64 v[104:105], v58 offset:1024
  ds_read_b64 v[106:107], v58 offset:1032
  ds_read_b64 v[136:137], v59 offset:2560
  ds_read_b64 v[138:139], v59 offset:2568
  ds_read_b64 v[108:109], v58 offset:1536
  ds_read_b64 v[110:111], v58 offset:1544
  ds_read_b64 v[140:141], v59 offset:2048
  ds_read_b64 v[142:143], v59 offset:2056
  ds_read_b64 v[112:113], v58 offset:2048
  ds_read_b64 v[114:115], v58 offset:2056
  ds_read_b64 v[144:145], v59 offset:1536
  ds_read_b64 v[146:147], v59 offset:1544
  ds_read_b64 v[116:117], v58 offset:2560
  ds_read_b64 v[118:119], v58 offset:2568
  ds_read_b64 v[148:149], v59 offset:1024
  ds_read_b64 v[150:151], v59 offset:1032
  ds_read_b64 v[120:121], v58 offset:3072
  ds_read_b64 v[122:123], v58 offset:3080
  ds_read_b64 v[152:153], v59 offset:512
  ds_read_b64 v[154:155], v59 offset:520
  ds_read_b64 v[124:125], v58 offset:3584
  ds_read_b64 v[126:127], v58 offset:3592
  ds_read_b64 v[156:157], v59 offset:0
  ds_read_b64 v[158:159], v59 offset:8
  s_setprio 0
  s_waitcnt lgkmcnt(15)
  v_mfma_f32_16x16x32_bf16 v[64:67], v[96:99], v[128:131], v[64:67]
  s_waitcnt lgkmcnt(15)
  v_mfma_f32_16x16x32_bf16 v[76:79], v[104:107], v[132:135], v[76:79]
  s_waitcnt lgkmcnt(15)
  v_mfma_f32_16x16x32_bf16 v[76:79], v[100:103], v[136:139], v[76:79]
  v_mfma_f32_16x16x32_bf16 v[80:83], v[104:107], v[136:139], v[80:83]
  s_waitcnt lgkmcnt(15)
  v_mfma_f32_16x16x32_bf16 v[76:79], v[108:111], v[128:131], v[76:79]
  v_mfma_f32_16x16x32_bf16 v[80:83], v[108:111], v[132:135], v[80:83]
  s_waitcnt lgkmcnt(15)
  v_mfma_f32_16x16x32_bf16 v[76:79], v[96:99], v[140:143], v[76:79]
  v_mfma_f32_16x16x32_bf16 v[80:83], v[100:103], v[140:143], v[80:83]
  s_waitcnt lgkmcnt(14)
  v_mfma_f32_16x16x32_bf16 v[80:83], v[112:115], v[128:131], v[80:83]
  v_mfma_f32_16x16x32_bf16 v[92:95], v[112:115], v[140:143], v[92:95]
  s_waitcnt lgkmcnt(12)
  v_mfma_f32_16x16x32_bf16 v[80:83], v[96:99], v[144:147], v[80:83]
  v_mfma_f32_16x16x32_bf16 v[92:95], v[108:111], v[144:147], v[92:95]
  s_waitcnt lgkmcnt(10)
  v_mfma_f32_16x16x32_bf16 v[92:95], v[116:119], v[136:139], v[92:95]
  s_waitcnt lgkmcnt(8)
  v_mfma_f32_16x16x32_bf16 v[92:95], v[104:107], v[148:151], v[92:95]
  s_waitcnt lgkmcnt(6)
  v_mfma_f32_16x16x32_bf16 v[92:95], v[120:123], v[132:135], v[92:95]
  s_waitcnt lgkmcnt(4)
  v_mfma_f32_16x16x32_bf16 v[92:95], v[100:103], v[152:155], v[92:95]
  s_waitcnt lgkmcnt(2)
  v_mfma_f32_16x16x32_bf16 v[92:95], v[124:127], v[128:131], v[92:95]
  s_waitcnt lgkmcnt(0)
  v_mfma_f32_16x16x32_bf16 v[92:95], v[96:99], v[156:159], v[92:95]
  s_setprio 3
  s_cmp_lg_u32 s3, 0
  s_cbranch_scc1 attn_kernel_wp2_0e
  v_add_u32 v58, 82176, v2
  v_mov_b32 v34, v64
  v_mov_b32 v35, v65
  v_mov_b32 v36, v66
  v_mov_b32 v37, v67
  ds_write_b128 v58, v[76:79] offset:5120
  ds_write_b128 v58, v[80:83] offset:7168
  ds_write_b128 v58, v[92:95] offset:9216
attn_kernel_wp2_0e:
  s_cmp_lg_u32 s3, 1
  s_cbranch_scc1 attn_kernel_wp2_1e
  v_add_u32 v58, 82176, v2
  ds_write_b128 v58, v[64:67] offset:0
  v_mov_b32 v34, v76
  v_mov_b32 v35, v77
  v_mov_b32 v36, v78
  v_mov_b32 v37, v79
  ds_write_b128 v58, v[80:83] offset:8192
  ds_write_b128 v58, v[92:95] offset:10240
attn_kernel_wp2_1e:
  s_cmp_lg_u32 s3, 2
  s_cbranch_scc1 attn_kernel_wp2_2e
  v_add_u32 v58, 82176, v2
  ds_write_b128 v58, v[64:67] offset:1024
  ds_write_b128 v58, v[76:79] offset:3072
  v_mov_b32 v34, v80
  v_mov_b32 v35, v81
  v_mov_b32 v36, v82
  v_mov_b32 v37, v83
  ds_write_b128 v58, v[92:95] offset:11264
attn_kernel_wp2_2e:
  s_cmp_lg_u32 s3, 3
  s_cbranch_scc1 attn_kernel_wp2_3e
  v_add_u32 v58, 82176, v2
  ds_write_b128 v58, v[64:67] offset:2048
  ds_write_b128 v58, v[76:79] offset:4096
  ds_write_b128 v58, v[80:83] offset:6144
  v_mov_b32 v34, v92
  v_mov_b32 v35, v93
  v_mov_b32 v36, v94
  v_mov_b32 v37, v95
attn_kernel_wp2_3e:
  s_waitcnt lgkmcnt(0)
  s_setprio 0
  s_branch attn_kernel_pd_2
attn_kernel_po_1:
  s_setprio 3
  v_add_u32 v58, 64512, v7
  v_add_u32 v59, 64512, v12
  ds_read_b64 v[96:97], v58 offset:0
  ds_read_b64 v[98:99], v58 offset:8
  ds_read_b64 v[128:129], v59 offset:3584
  ds_read_b64 v[130:131], v59 offset:3592
  ds_read_b64 v[100:101], v58 offset:512
  ds_read_b64 v[102:103], v58 offset:520
  ds_read_b64 v[132:133], v59 offset:3072
  ds_read_b64 v[134:135], v59 offset:3080
  ds_read_b64 v[104:105], v58 offset:1024
  ds_read_b64 v[106:107], v58 offset:1032
  ds_read_b64 v[136:137], v59 offset:2560
  ds_read_b64 v[138:139], v59 offset:2568
  ds_read_b64 v[108:109], v58 offset:1536
  ds_read_b64 v[110:111], v58 offset:1544
  ds_read_b64 v[140:141], v59 offset:2048
  ds_read_b64 v[142:143], v59 offset:2056
  ds_read_b64 v[112:113], v58 offset:2048
  ds_read_b64 v[114:115], v58 offset:2056
  ds_read_b64 v[144:145], v59 offset:1536
  ds_read_b64 v[146:147], v59 offset:1544
  ds_read_b64 v[116:117], v58 offset:2560
  ds_read_b64 v[118:119], v58 offset:2568
  ds_read_b64 v[148:149], v59 offset:1024
  ds_read_b64 v[150:151], v59 offset:1032
  ds_read_b64 v[120:121], v58 offset:3072
  ds_read_b64 v[122:123], v58 offset:3080
  ds_read_b64 v[152:153], v59 offset:512
  ds_read_b64 v[154:155], v59 offset:520
  s_setprio 0
  s_waitcnt lgkmcnt(15)
  v_mfma_f32_16x16x32_bf16 v[68:71], v[100:103], v[128:131], 0
  s_waitcnt lgkmcnt(15)
  v_mfma_f32_16x16x32_bf16 v[68:71], v[96:99], v[132:135], v[68:71]
  v_mfma_f32_16x16x32_bf16 v[72:75], v[100:103], v[132:135], 0
  s_waitcnt lgkmcnt(15)
  v_mfma_f32_16x16x32_bf16 v[72:75], v[104:107], v[128:131], v[72:75]
  s_waitcnt lgkmcnt(15)
  v_mfma_f32_16x16x32_bf16 v[72:75], v[96:99], v[136:139], v[72:75]
  s_waitcnt lgkmcnt(14)
  v_mfma_f32_16x16x32_bf16 v[84:87], v[108:111], v[136:139], 0
  s_waitcnt lgkmcnt(12)
  v_mfma_f32_16x16x32_bf16 v[84:87], v[104:107], v[140:143], v[84:87]
  v_mfma_f32_16x16x32_bf16 v[88:91], v[108:111], v[140:143], 0
  s_waitcnt lgkmcnt(10)
  v_mfma_f32_16x16x32_bf16 v[84:87], v[112:115], v[132:135], v[84:87]
  v_mfma_f32_16x16x32_bf16 v[88:91], v[112:115], v[136:139], v[88:91]
  s_waitcnt lgkmcnt(8)
  v_mfma_f32_16x16x32_bf16 v[84:87], v[100:103], v[144:147], v[84:87]
  v_mfma_f32_16x16x32_bf16 v[88:91], v[104:107], v[144:147], v[88:91]
  s_waitcnt lgkmcnt(6)
  v_mfma_f32_16x16x32_bf16 v[84:87], v[116:119], v[128:131], v[84:87]
  v_mfma_f32_16x16x32_bf16 v[88:91], v[116:119], v[132:135], v[88:91]
  s_waitcnt lgkmcnt(4)
  v_mfma_f32_16x16x32_bf16 v[84:87], v[96:99], v[148:151], v[84:87]
  v_mfma_f32_16x16x32_bf16 v[88:91], v[100:103], v[148:151], v[88:91]
  s_waitcnt lgkmcnt(2)
  v_mfma_f32_16x16x32_bf16 v[88:91], v[120:123], v[128:131], v[88:91]
  s_waitcnt lgkmcnt(0)
  v_mfma_f32_16x16x32_bf16 v[88:91], v[96:99], v[152:155], v[88:91]
  s_cmp_lg_u32 s3, 0
  s_cbranch_scc1 attn_kernel_dt2o
  v_and_b32 v42, s69, v14
  v_and_b32 v43, s69, v15
  v_and_b32 v44, s69, v16
  v_and_b32 v45, s69, v17
  s_nop 1
  v_mfma_f32_16x16x32_bf16 v[68:71], v[42:45], v[132:135], v[68:71]
  v_mfma_f32_16x16x32_bf16 v[72:75], v[42:45], v[136:139], v[72:75]
  v_mfma_f32_16x16x32_bf16 v[84:87], v[42:45], v[148:151], v[84:87]
  v_mfma_f32_16x16x32_bf16 v[88:91], v[42:45], v[152:155], v[88:91]
attn_kernel_dt2o:
  s_setprio 3
  v_add_u32 v58, 64576, v7
  v_add_u32 v59, 64512, v13
  ds_read_b64 v[96:97], v58 offset:0
  ds_read_b64 v[98:99], v58 offset:8
  ds_read_b64 v[128:129], v59 offset:3584
  ds_read_b64 v[130:131], v59 offset:3592
  ds_read_b64 v[100:101], v58 offset:512
  ds_read_b64 v[102:103], v58 offset:520
  ds_read_b64 v[132:133], v59 offset:3072
  ds_read_b64 v[134:135], v59 offset:3080
  ds_read_b64 v[104:105], v58 offset:1024
  ds_read_b64 v[106:107], v58 offset:1032
  ds_read_b64 v[136:137], v59 offset:2560
  ds_read_b64 v[138:139], v59 offset:2568
  ds_read_b64 v[108:109], v58 offset:1536
  ds_read_b64 v[110:111], v58 offset:1544
  ds_read_b64 v[140:141], v59 offset:2048
  ds_read_b64 v[142:143], v59 offset:2056
  ds_read_b64 v[112:113], v58 offset:2048
  ds_read_b64 v[114:115], v58 offset:2056
  ds_read_b64 v[144:145], v59 offset:1536
  ds_read_b64 v[146:147], v59 offset:1544
  ds_read_b64 v[116:117], v58 offset:2560
  ds_read_b64 v[118:119], v58 offset:2568
  ds_read_b64 v[148:149], v59 offset:1024
  ds_read_b64 v[150:151], v59 offset:1032
  ds_read_b64 v[120:121], v58 offset:3072
  ds_read_b64 v[122:123], v58 offset:3080
  ds_read_b64 v[152:153], v59 offset:512
  ds_read_b64 v[154:155], v59 offset:520
  s_setprio 0
  s_waitcnt lgkmcnt(15)
  v_mfma_f32_16x16x32_bf16 v[68:71], v[100:103], v[128:131], v[68:71]
  s_waitcnt lgkmcnt(15)
  v_mfma_f32_16x16x32_bf16 v[68:71], v[96:99], v[132:135], v[68:71]
  v_mfma_f32_16x16x32_bf16 v[72:75], v[100:103], v[132:135], v[72:75]
  s_waitcnt lgkmcnt(15)
  v_mfma_f32_16x16x32_bf16 v[72:75], v[104:107], v[128:131], v[72:75]
  s_waitcnt lgkmcnt(15)
  v_mfma_f32_16x16x32_bf16 v[72:75], v[96:99], v[136:139], v[72:75]
  s_waitcnt lgkmcnt(14)
  v_mfma_f32_16x16x32_bf16 v[84:87], v[108:111], v[136:139], v[84:87]
  s_waitcnt lgkmcnt(12)
  v_mfma_f32_16x16x32_bf16 v[84:87], v[104:107], v[140:143], v[84:87]
  v_mfma_f32_16x16x32_bf16 v[88:91], v[108:111], v[140:143], v[88:91]
  s_waitcnt lgkmcnt(10)
  v_mfma_f32_16x16x32_bf16 v[84:87], v[112:115], v[132:135], v[84:87]
  v_mfma_f32_16x16x32_bf16 v[88:91], v[112:115], v[136:139], v[88:91]
  s_waitcnt lgkmcnt(8)
  v_mfma_f32_16x16x32_bf16 v[84:87], v[100:103], v[144:147], v[84:87]
  v_mfma_f32_16x16x32_bf16 v[88:91], v[104:107], v[144:147], v[88:91]
  s_waitcnt lgkmcnt(6)
  v_mfma_f32_16x16x32_bf16 v[84:87], v[116:119], v[128:131], v[84:87]
  v_mfma_f32_16x16x32_bf16 v[88:91], v[116:119], v[132:135], v[88:91]
  s_waitcnt lgkmcnt(4)
  v_mfma_f32_16x16x32_bf16 v[84:87], v[96:99], v[148:151], v[84:87]
  v_mfma_f32_16x16x32_bf16 v[88:91], v[100:103], v[148:151], v[88:91]
  s_waitcnt lgkmcnt(2)
  v_mfma_f32_16x16x32_bf16 v[88:91], v[120:123], v[128:131], v[88:91]
  s_waitcnt lgkmcnt(0)
  v_mfma_f32_16x16x32_bf16 v[88:91], v[96:99], v[152:155], v[88:91]
  s_setprio 3
  s_cmp_lg_u32 s3, 0
  s_cbranch_scc1 attn_kernel_wp2_0o
  v_add_u32 v58, 82176, v2
  v_mov_b32 v34, v68
  v_mov_b32 v35, v69
  v_mov_b32 v36, v70
  v_mov_b32 v37, v71
  ds_write_b128 v58, v[72:75] offset:5120
  ds_write_b128 v58, v[84:87] offset:7168
  ds_write_b128 v58, v[88:91] offset:9216
attn_kernel_wp2_0o:
  s_cmp_lg_u32 s3, 1
  s_cbranch_scc1 attn_kernel_wp2_1o
  v_add_u32 v58, 82176, v2
  ds_write_b128 v58, v[68:71] offset:0
  v_mov_b32 v34, v72
  v_mov_b32 v35, v73
  v_mov_b32 v36, v74
  v_mov_b32 v37, v75
  ds_write_b128 v58, v[84:87] offset:8192
  ds_write_b128 v58, v[88:91] offset:10240
attn_kernel_wp2_1o:
  s_cmp_lg_u32 s3, 2
  s_cbranch_scc1 attn_kernel_wp2_2o
  v_add_u32 v58, 82176, v2
  ds_write_b128 v58, v[68:71] offset:1024
  ds_write_b128 v58, v[72:75] offset:3072
  v_mov_b32 v34, v84
  v_mov_b32 v35, v85
  v_mov_b32 v36, v86
  v_mov_b32 v37, v87
  ds_write_b128 v58, v[88:91] offset:11264
attn_kernel_wp2_2o:
  s_cmp_lg_u32 s3, 3
  s_cbranch_scc1 attn_kernel_wp2_3o
  v_add_u32 v58, 82176, v2
  ds_write_b128 v58, v[68:71] offset:2048
  ds_write_b128 v58, v[72:75] offset:4096
  ds_write_b128 v58, v[84:87] offset:6144
  v_mov_b32 v34, v88
  v_mov_b32 v35, v89
  v_mov_b32 v36, v90
  v_mov_b32 v37, v91
attn_kernel_wp2_3o:
  s_waitcnt lgkmcnt(0)
  s_setprio 0
attn_kernel_pd_2:
  s_waitcnt vmcnt(0) lgkmcnt(0)
  s_barrier
  s_setprio 3
  s_add_u32 m0, s35, 21504
  s_add_u32 s52, s50, 150528
  buffer_load_dwordx4 v2, s[8:11], s52 offen lds
  s_add_u32 m0, s35, 25600
  s_add_u32 s52, s50, 154624
  buffer_load_dwordx4 v2, s[8:11], s52 offen lds
  s_add_u32 m0, s35, 29696
  s_add_u32 s52, s50, 158720
  buffer_load_dwordx4 v2, s[8:11], s52 offen lds
  s_add_u32 m0, s35, 33792
  s_add_u32 s52, s50, 162816
  buffer_load_dwordx4 v2, s[8:11], s52 offen lds
  s_add_u32 m0, s35, 37888
  s_add_u32 s52, s50, 166912
  buffer_load_dwordx4 v2, s[8:11], s52 offen lds
  s_cmp_lg_u32 s3, 0
  s_cbranch_scc1 attn_kernel_kv5_7
  s_add_u32 m0, s35, 41984
  s_add_u32 s52, s50, 171008
  buffer_load_dwordx4 v2, s[8:11], s52 offen lds
attn_kernel_kv5_7:
  s_setprio 0
  s_setprio 3
  s_mul_i32 s52, s3, 3072
  s_add_u32 s52, s52, 82176
  v_add_u32 v58, s52, v2
  ds_read_b128 v[18:21], v58 offset:0
  ds_read_b128 v[22:25], v58 offset:1024
  ds_read_b128 v[26:29], v58 offset:2048
  s_waitcnt lgkmcnt(0)
  v_add_f32 v18, v18, v22
  v_add_f32 v34, v34, v26
  v_add_f32 v18, v18, v34
  v_add_f32 v19, v19, v23
  v_add_f32 v35, v35, v27
  v_add_f32 v19, v19, v35
  v_add_f32 v20, v20, v24
  v_add_f32 v36, v36, v28
  v_add_f32 v20, v20, v36
  v_add_f32 v21, v21, v25
  v_add_f32 v37, v37, v29
  v_add_f32 v21, v21, v37
  v_cvt_pk_bf16_f32 v30, v18, v19
  v_cvt_pk_bf16_f32 v31, v20, v21
  s_and_b32 s53, s2, 1
  s_cmp_eq_u32 s53, 0
  s_mov_b32 s54, 0x6521
  s_cselect_b32 s53, 0x7430, s54
  s_lshl_b32 s54, s3, 2
  s_lshr_b32 s53, s53, s54
  s_and_b32 s53, s53, 15
  s_lshl_b32 s53, s53, 9
  s_lshl_b32 s54, s66, 12
  s_add_u32 s53, s53, s54
  s_add_u32 s53, s53, 13549568
  v_lshlrev_b32 v59, 3, v1
  buffer_store_dwordx2 v[30:31], v59, s[8:11], s53 offen sc1
  s_setprio 0
  s_lshl_b32 s52, s2, 2
  s_add_u32 s52, s52, s3
  s_lshl_b32 s52, s52, 2
  s_add_u32 s52, s52, 17022976
  v_mov_b32 v58, s34
  v_mov_b32 v59, 0
  s_waitcnt vmcnt(0) lgkmcnt(0)
  s_mov_b64 exec, 1
  buffer_store_dword v58, v59, s[8:11], s52 offen sc1
  s_mov_b64 exec, -1
  s_barrier
  s_setprio 3
  s_lshl_b32 s52, s3, 10
  s_add_u32 m0, s52, 64512
  s_add_u32 s52, s52, s51
  s_add_u32 s52, s52, 0
  buffer_load_dwordx4 v2, s[8:11], s52 offen lds
  s_lshl_b32 s52, s3, 10
  s_add_u32 m0, s52, 68608
  s_add_u32 s52, s52, s51
  s_add_u32 s52, s52, 4096
  buffer_load_dwordx4 v2, s[8:11], s52 offen lds
  s_lshl_b32 s52, s3, 10
  s_add_u32 m0, s52, 72704
  s_add_u32 s52, s52, s51
  s_add_u32 s52, s52, 8192
  buffer_load_dwordx4 v2, s[8:11], s52 offen lds
  s_lshl_b32 s52, s3, 10
  s_add_u32 m0, s52, 76800
  s_add_u32 s52, s52, s51
  s_add_u32 s52, s52, 12288
  buffer_load_dwordx4 v2, s[8:11], s52 offen lds
  s_lshl_b32 s52, s3, 10
  s_add_u32 m0, s52, 80896
  s_add_u32 s52, s52, s51
  s_add_u32 s52, s52, 16384
  buffer_load_dwordx4 v2, s[8:11], s52 offen lds
  s_lshl_b32 s52, s3, 10
  s_add_u32 m0, s52, 84992
  s_add_u32 s52, s52, s51
  s_add_u32 s52, s52, 20480
  buffer_load_dwordx4 v2, s[8:11], s52 offen lds
  s_lshl_b32 s52, s3, 10
  s_add_u32 m0, s52, 89088
  s_add_u32 s52, s52, s51
  s_add_u32 s52, s52, 24576
  buffer_load_dwordx4 v2, s[8:11], s52 offen lds
  s_lshl_b32 s52, s3, 10
  s_add_u32 m0, s52, 93184
  s_add_u32 s52, s52, s51
  s_add_u32 s52, s52, 28672
  buffer_load_dwordx4 v2, s[8:11], s52 offen lds
  s_lshl_b32 s52, s3, 10
  s_add_u32 m0, s52, 97280
  s_add_u32 s52, s52, s51
  s_add_u32 s52, s52, 32768
  buffer_load_dwordx4 v2, s[8:11], s52 offen lds
  s_lshl_b32 s52, s3, 10
  s_add_u32 m0, s52, 101376
  s_add_u32 s52, s52, s51
  s_add_u32 s52, s52, 36864
  buffer_load_dwordx4 v2, s[8:11], s52 offen lds
  s_lshl_b32 s52, s3, 10
  s_add_u32 m0, s52, 105472
  s_add_u32 s52, s52, s51
  s_add_u32 s52, s52, 40960
  buffer_load_dwordx4 v2, s[8:11], s52 offen lds
  s_lshl_b32 s52, s3, 10
  s_add_u32 m0, s52, 109568
  s_add_u32 s52, s52, s51
  s_add_u32 s52, s52, 45056
  buffer_load_dwordx4 v2, s[8:11], s52 offen lds
  s_lshl_b32 s52, s3, 10
  s_add_u32 m0, s52, 113664
  s_add_u32 s52, s52, s51
  s_add_u32 s52, s52, 49152
  buffer_load_dwordx4 v2, s[8:11], s52 offen lds
  s_lshl_b32 s52, s3, 10
  s_add_u32 m0, s52, 117760
  s_add_u32 s52, s52, s51
  s_add_u32 s52, s52, 53248
  buffer_load_dwordx4 v2, s[8:11], s52 offen lds
  s_cmp_ge_u32 s3, 3
  s_cbranch_scc1 attn_kernel_wos_3
  s_lshl_b32 s52, s3, 10
  s_add_u32 m0, s52, 121856
  s_add_u32 s52, s52, s51
  s_add_u32 s52, s52, 57344
  buffer_load_dwordx4 v2, s[8:11], s52 offen lds
attn_kernel_wos_3:
  s_setprio 0
  s_setprio 3
  s_lshl_b32 s52, s3, 10
  s_add_u32 m0, s52, 55296
  s_add_u32 s52, s52, s51
  s_add_u32 s52, s52, 97280
  buffer_load_dwordx4 v2, s[8:11], s52 offen lds
  s_cmp_ge_u32 s3, 1
  s_cbranch_scc1 attn_kernel_wos_4
  s_lshl_b32 s52, s3, 10
  s_add_u32 m0, s52, 59392
  s_add_u32 s52, s52, s51
  s_add_u32 s52, s52, 101376
  buffer_load_dwordx4 v2, s[8:11], s52 offen lds
attn_kernel_wos_4:
  s_setprio 0
  s_mov_b32 s16, s44
  s_and_b32 s17, s45, 0xffff
  s_mov_b32 s18, 2621440
  s_mov_b32 s19, 0x00020000
  s_mov_b32 s24, s40
  s_and_b32 s25, s41, 0xffff
  s_mov_b32 s26, 2621440
  s_mov_b32 s27, 0x00020000
  v_and_b32 v3, 15, v1
  s_lshl_b32 s52, s3, 4
  v_add_u32 v3, s52, v3
  v_lshrrev_b32 v4, 3, v3
  v_lshlrev_b32 v4, 5, v4
  v_bfe_u32 v5, v3, 2, 1
  v_add_u32 v4, v4, v5
  v_and_b32 v5, 3, v3
  v_lshl_add_u32 v4, v5, 1, v4
  s_lshl_b32 s52, s47, 8
  s_lshl_b32 s53, s48, 3
  s_add_u32 s52, s52, s53
  v_add_u32 v4, s52, v4
  v_lshrrev_b32 v5, 4, v1
  v_mul_u32_u24 v6, 1280, v4
  v_lshl_add_u32 v12, v5, 3, v6
  s_mul_i32 s50, s49, 160
  buffer_load_dwordx2 v[34:35], v12, s[16:19], s50 offen offset:0
  buffer_load_dwordx2 v[36:37], v12, s[16:19], s50 offen offset:32
  buffer_load_dwordx2 v[38:39], v12, s[16:19], s50 offen offset:64
  buffer_load_dwordx2 v[40:41], v12, s[16:19], s50 offen offset:96
  buffer_load_dwordx2 v[42:43], v12, s[16:19], s50 offen offset:128
  v_lshlrev_b32 v13, 2, v4
  v_add_u32 v13, 10911744, v13
  buffer_load_dword v44, v13, s[8:11], 0 offen
  s_barrier
  s_setprio 0
  s_mov_b32 s54, 17022976
  s_cmp_lg_u32 s3, 0
  s_cbranch_scc1 attn_kernel_polld_c
  s_mov_b32 s53, 0
attn_kernel_poll_c:
  buffer_load_dwordx4 v[18:21], v2, s[8:11], s54 offen offset:0 sc1
  buffer_load_dwordx4 v[22:25], v2, s[8:11], s54 offen offset:1024 sc1
  buffer_load_dwordx4 v[26:29], v2, s[8:11], s54 offen offset:2048 sc1
  buffer_load_dwordx4 v[30:33], v2, s[8:11], s54 offen offset:3072 sc1
  s_waitcnt vmcnt(0)
  v_mov_b32 v63, 0
  v_xor_b32 v62, s34, v18
  v_or_b32 v63, v63, v62
  v_xor_b32 v62, s34, v19
  v_or_b32 v63, v63, v62
  v_xor_b32 v62, s34, v20
  v_or_b32 v63, v63, v62
  v_xor_b32 v62, s34, v21
  v_or_b32 v63, v63, v62
  v_xor_b32 v62, s34, v22
  v_or_b32 v63, v63, v62
  v_xor_b32 v62, s34, v23
  v_or_b32 v63, v63, v62
  v_xor_b32 v62, s34, v24
  v_or_b32 v63, v63, v62
  v_xor_b32 v62, s34, v25
  v_or_b32 v63, v63, v62
  v_xor_b32 v62, s34, v26
  v_or_b32 v63, v63, v62
  v_xor_b32 v62, s34, v27
  v_or_b32 v63, v63, v62
  v_xor_b32 v62, s34, v28
  v_or_b32 v63, v63, v62
  v_xor_b32 v62, s34, v29
  v_or_b32 v63, v63, v62
  v_xor_b32 v62, s34, v30
  v_or_b32 v63, v63, v62
  v_xor_b32 v62, s34, v31
  v_or_b32 v63, v63, v62
  v_xor_b32 v62, s34, v32
  v_or_b32 v63, v63, v62
  v_xor_b32 v62, s34, v33
  v_or_b32 v63, v63, v62
  v_cmp_ne_u32 vcc, 0, v63
  s_cbranch_vccz attn_kernel_polld_c
  s_sleep 8
  s_add_u32 s53, s53, 1
  s_cmp_lt_u32 s53, 0x40000
  s_cbranch_scc1 attn_kernel_poll_c
attn_kernel_polld_c:
  s_waitcnt vmcnt(0) lgkmcnt(0)
  ds_add_u32 v60, v61 offset:12
attn_kernel_as_5:
  ds_read_b32 v63, v60 offset:12
  s_waitcnt lgkmcnt(0)
  v_readfirstlane_b32 s63, v63
  s_nop 0
  s_cmp_ge_u32 s63, 256
  s_cbranch_scc1 attn_kernel_asd_6
  s_sleep 2
  s_branch attn_kernel_as_5
attn_kernel_asd_6:
  v_lshrrev_b32 v7, 1, v1
  v_lshlrev_b32 v7, 12, v7
  v_and_b32 v8, 1, v1
  v_lshl_add_u32 v7, v8, 4, v7
  s_mul_i32 s52, s49, 327680
  s_lshl_b32 s53, s47, 9
  s_add_u32 s52, s52, s53
  s_lshl_b32 s53, s48, 7
  s_add_u32 s52, s52, s53
  s_lshl_b32 s53, s3, 5
  s_add_u32 s52, s52, s53
  s_add_u32 s52, s52, 13549568
  s_add_u32 s53, s52, 0
  buffer_load_dwordx4 v[144:147], v7, s[8:11], s53 offen sc1
  s_add_u32 s53, s52, 131072
  buffer_load_dwordx4 v[148:151], v7, s[8:11], s53 offen sc1
  s_mov_b64 exec, 0xffffffff
  s_add_u32 s53, s52, 262144
  buffer_load_dwordx4 v[152:155], v7, s[8:11], s53 offen sc1
  s_mov_b64 exec, -1
  s_waitcnt vmcnt(0)
  s_mul_i32 s53, s3, 2560
  s_add_u32 s53, s53, 12288
  s_cmp_eq_u32 s3, 3
  s_cselect_b32 s53, 60416, s53
  v_add_u32 v8, s53, v2
  ds_write_b128 v8, v[144:147] offset:0
  ds_write_b128 v8, v[148:151] offset:1024
  s_mov_b64 exec, 0xffffffff
  ds_write_b128 v8, v[152:155] offset:2048
  s_mov_b64 exec, -1
  v_bfe_u32 v15, v1, 2, 2
  v_lshl_add_u32 v15, v5, 2, v15
  v_lshlrev_b32 v15, 5, v15
  v_and_b32 v14, 3, v1
  v_lshl_add_u32 v15, v14, 3, v15
  v_add_u32 v15, s53, v15
  s_waitcnt lgkmcnt(0)
  ds_read_b64_tr_b16 v[64:65], v15 offset:0
  ds_read_b64_tr_b16 v[66:67], v15 offset:512
  ds_read_b64_tr_b16 v[68:69], v15 offset:1024
  ds_read_b64_tr_b16 v[70:71], v15 offset:1536
  ds_read_b64_tr_b16 v[72:73], v15 offset:2048
  v_sub_f32 v45, 1.0, v44
  s_mov_b32 s57, 0xffff0000
  v_add_u32 v9, 64512, v2
  v_add_u32 v10, 115712, v2
  s_lshl_b32 s56, s47, 2
  s_add_u32 s56, s56, s48
  s_lshl_b32 s56, s56, 2
  s_add_u32 s56, s56, s3
  s_lshl_b32 s56, s56, 14
  s_add_u32 s56, s56, 10928128
  v_lshlrev_b32 v11, 15, v5
  v_lshl_add_u32 v11, v4, 3, v11
  s_waitcnt lgkmcnt(0)
  v_lshlrev_b32 v80, 16, v34
  v_and_b32 v81, s57, v34
  v_lshlrev_b32 v82, 16, v64
  v_and_b32 v83, s57, v64
  v_mul_f32 v80, v80, v82
  v_mul_f32 v81, v81, v83
  v_mul_f32 v50, v80, v45
  v_mul_f32 v51, v81, v45
  v_lshlrev_b32 v80, 16, v35
  v_and_b32 v81, s57, v35
  v_lshlrev_b32 v82, 16, v65
  v_and_b32 v83, s57, v65
  v_mul_f32 v80, v80, v82
  v_mul_f32 v81, v81, v83
  v_mul_f32 v52, v80, v45
  v_mul_f32 v53, v81, v45
  v_lshlrev_b32 v80, 16, v36
  v_and_b32 v81, s57, v36
  v_lshlrev_b32 v82, 16, v66
  v_and_b32 v83, s57, v66
  v_mul_f32 v80, v80, v82
  v_mul_f32 v81, v81, v83
  v_mul_f32 v54, v80, v45
  v_mul_f32 v55, v81, v45
  v_lshlrev_b32 v80, 16, v37
  v_and_b32 v81, s57, v37
  v_lshlrev_b32 v82, 16, v67
  v_and_b32 v83, s57, v67
  v_mul_f32 v80, v80, v82
  v_mul_f32 v81, v81, v83
  v_mul_f32 v56, v80, v45
  v_mul_f32 v57, v81, v45
  v_lshlrev_b32 v80, 16, v38
  v_and_b32 v81, s57, v38
  v_lshlrev_b32 v82, 16, v68
  v_and_b32 v83, s57, v68
  v_mul_f32 v80, v80, v82
  v_mul_f32 v81, v81, v83
  v_mul_f32 v58, v80, v45
  v_mul_f32 v59, v81, v45
  v_lshlrev_b32 v80, 16, v39
  v_and_b32 v81, s57, v39
  v_lshlrev_b32 v82, 16, v69
  v_and_b32 v83, s57, v69
  v_mul_f32 v80, v80, v82
  v_mul_f32 v81, v81, v83
  v_mul_f32 v34, v80, v45
  v_mul_f32 v35, v81, v45
  v_lshlrev_b32 v80, 16, v40
  v_and_b32 v81, s57, v40
  v_lshlrev_b32 v82, 16, v70
  v_and_b32 v83, s57, v70
  v_mul_f32 v80, v80, v82
  v_mul_f32 v81, v81, v83
  v_mul_f32 v36, v80, v45
  v_mul_f32 v37, v81, v45
  v_lshlrev_b32 v80, 16, v41
  v_and_b32 v81, s57, v41
  v_lshlrev_b32 v82, 16, v71
  v_and_b32 v83, s57, v71
  v_mul_f32 v80, v80, v82
  v_mul_f32 v81, v81, v83
  v_mul_f32 v38, v80, v45
  v_mul_f32 v39, v81, v45
  v_lshlrev_b32 v80, 16, v42
  v_and_b32 v81, s57, v42
  v_lshlrev_b32 v82, 16, v72
  v_and_b32 v83, s57, v72
  v_mul_f32 v80, v80, v82
  v_mul_f32 v81, v81, v83
  v_mul_f32 v40, v80, v45
  v_mul_f32 v41, v81, v45
  v_lshlrev_b32 v80, 16, v43
  v_and_b32 v81, s57, v43
  v_lshlrev_b32 v82, 16, v73
  v_and_b32 v83, s57, v73
  v_mul_f32 v80, v80, v82
  v_mul_f32 v81, v81, v83
  v_mul_f32 v42, v80, v45
  v_mul_f32 v43, v81, v45
  v_add_u32 v13, 55296, v2
  ds_read_b128 v[14:17], v10 offset:30720
  ds_read_b128 v[18:21], v10 offset:31744
  ds_read_b128 v[22:25], v10 offset:32768
  ds_read_b128 v[26:29], v10 offset:33792
  ds_read_b128 v[30:33], v10 offset:34816
attn_kernel_espinp:
  ds_read_b32 v63, v60 offset:4
  s_waitcnt lgkmcnt(0)
  v_readfirstlane_b32 s63, v63
  s_nop 0
  s_and_b32 s63, s63, 0xffff
  s_cmp_ge_u32 s63, 512
  s_cbranch_scc1 attn_kernel_espindp
  s_sleep 2
  s_branch attn_kernel_espinp
attn_kernel_espindp:
  s_setprio 2
  s_mov_b32 s55, 0
attn_kernel_probe:
  s_sleep 4
  s_mov_b32 s54, 13025280
  buffer_load_dwordx2 v[128:129], v11, s[8:11], s54 offen sc1
  s_mov_b32 s54, 13041664
  buffer_load_dwordx2 v[130:131], v11, s[8:11], s54 offen sc1
  s_mov_b32 s54, 13156352
  buffer_load_dwordx2 v[132:133], v11, s[8:11], s54 offen sc1
  s_mov_b32 s54, 13172736
  buffer_load_dwordx2 v[134:135], v11, s[8:11], s54 offen sc1
  s_mov_b32 s54, 13287424
  buffer_load_dwordx2 v[136:137], v11, s[8:11], s54 offen sc1
  s_mov_b32 s54, 13303808
  buffer_load_dwordx2 v[138:139], v11, s[8:11], s54 offen sc1
  s_mov_b32 s54, 13418496
  buffer_load_dwordx2 v[140:141], v11, s[8:11], s54 offen sc1
  s_mov_b32 s54, 13434880
  buffer_load_dwordx2 v[142:143], v11, s[8:11], s54 offen sc1
  s_waitcnt vmcnt(0)
  v_max_u32 v62, v128, v129
  v_max_u32 v63, v130, v131
  v_max3_u32 v62, v62, v132, v133
  v_max3_u32 v63, v63, v134, v135
  v_max3_u32 v62, v62, v136, v137
  v_max3_u32 v63, v63, v138, v139
  v_max3_u32 v62, v62, v140, v141
  v_max3_u32 v63, v63, v142, v143
  v_max_u32 v62, v62, v63
  v_cmp_eq_u32 vcc, -1, v62
  s_cbranch_vccz attn_kernel_probed
  s_add_u32 s55, s55, 1
  s_cmp_lt_u32 s55, 0x20000
  s_cbranch_scc1 attn_kernel_probe
attn_kernel_probed:
  s_add_u32 s54, s56, 0
  buffer_load_dwordx4 v[64:67], v2, s[8:11], s54 offen offset:0
  s_add_u32 s54, s56, 0
  buffer_load_dwordx4 v[68:71], v2, s[8:11], s54 offen offset:1024
  s_add_u32 s54, s56, 0
  buffer_load_dwordx4 v[72:75], v2, s[8:11], s54 offen offset:2048
  s_add_u32 s54, s56, 0
  buffer_load_dwordx4 v[76:79], v2, s[8:11], s54 offen offset:3072
  s_add_u32 s54, s56, 4096
  buffer_load_dwordx4 v[80:83], v2, s[8:11], s54 offen offset:0
  s_add_u32 s54, s56, 4096
  buffer_load_dwordx4 v[84:87], v2, s[8:11], s54 offen offset:1024
  s_add_u32 s54, s56, 4096
  buffer_load_dwordx4 v[88:91], v2, s[8:11], s54 offen offset:2048
  s_add_u32 s54, s56, 4096
  buffer_load_dwordx4 v[92:95], v2, s[8:11], s54 offen offset:3072
  s_add_u32 s54, s56, 8192
  buffer_load_dwordx4 v[96:99], v2, s[8:11], s54 offen offset:0
  s_add_u32 s54, s56, 8192
  buffer_load_dwordx4 v[100:103], v2, s[8:11], s54 offen offset:1024
  s_waitcnt lgkmcnt(4)
  v_mfma_f32_16x16x32_bf16 v[144:147], v[14:17], v[128:131], 0
  ds_read_b128 v[14:17], v10 offset:35840
  s_waitcnt lgkmcnt(4)
  v_mfma_f32_16x16x32_bf16 v[148:151], v[18:21], v[128:131], 0
  ds_read_b128 v[18:21], v10 offset:36864
  s_add_u32 s54, s56, 8192
  buffer_load_dwordx4 v[104:107], v2, s[8:11], s54 offen offset:2048
  s_waitcnt lgkmcnt(4)
  v_mfma_f32_16x16x32_bf16 v[152:155], v[22:25], v[128:131], 0
  ds_read_b128 v[22:25], v10 offset:37888
  s_waitcnt lgkmcnt(4)
  v_mfma_f32_16x16x32_bf16 v[156:159], v[26:29], v[128:131], 0
  ds_read_b128 v[26:29], v10 offset:38912
  s_add_u32 s54, s56, 8192
  buffer_load_dwordx4 v[108:111], v2, s[8:11], s54 offen offset:3072
  s_waitcnt lgkmcnt(4)
  v_mfma_f32_16x16x32_bf16 v[160:163], v[30:33], v[128:131], 0
  ds_read_b128 v[30:33], v10 offset:39936
  s_waitcnt lgkmcnt(4)
  v_mfma_f32_16x16x32_bf16 v[144:147], v[14:17], v[132:135], v[144:147]
  ds_read_b128 v[14:17], v10 offset:40960
  s_waitcnt lgkmcnt(4)
  v_mfma_f32_16x16x32_bf16 v[148:151], v[18:21], v[132:135], v[148:151]
  ds_read_b128 v[18:21], v10 offset:41984
  s_add_u32 s54, s56, 12288
  buffer_load_dwordx4 v[112:115], v2, s[8:11], s54 offen offset:0
  s_waitcnt lgkmcnt(4)
  v_mfma_f32_16x16x32_bf16 v[152:155], v[22:25], v[132:135], v[152:155]
  ds_read_b128 v[22:25], v10 offset:43008
  s_waitcnt lgkmcnt(4)
  v_mfma_f32_16x16x32_bf16 v[156:159], v[26:29], v[132:135], v[156:159]
  ds_read_b128 v[26:29], v10 offset:44032
  s_add_u32 s54, s56, 12288
  buffer_load_dwordx4 v[116:119], v2, s[8:11], s54 offen offset:1024
  s_waitcnt lgkmcnt(4)
  v_mfma_f32_16x16x32_bf16 v[160:163], v[30:33], v[132:135], v[160:163]
  ds_read_b128 v[30:33], v10 offset:45056
  s_waitcnt lgkmcnt(4)
  v_mfma_f32_16x16x32_bf16 v[144:147], v[14:17], v[136:139], v[144:147]
  ds_read_b128 v[14:17], v13 offset:0
  s_waitcnt lgkmcnt(4)
  v_mfma_f32_16x16x32_bf16 v[148:151], v[18:21], v[136:139], v[148:151]
  ds_read_b128 v[18:21], v13 offset:1024
  s_add_u32 s54, s56, 12288
  buffer_load_dwordx4 v[120:123], v2, s[8:11], s54 offen offset:2048
  s_waitcnt lgkmcnt(4)
  v_mfma_f32_16x16x32_bf16 v[152:155], v[22:25], v[136:139], v[152:155]
  ds_read_b128 v[22:25], v13 offset:2048
  s_waitcnt lgkmcnt(4)
  v_mfma_f32_16x16x32_bf16 v[156:159], v[26:29], v[136:139], v[156:159]
  ds_read_b128 v[26:29], v13 offset:3072
  s_add_u32 s54, s56, 12288
  buffer_load_dwordx4 v[124:127], v2, s[8:11], s54 offen offset:3072
  s_waitcnt lgkmcnt(4)
  v_mfma_f32_16x16x32_bf16 v[160:163], v[30:33], v[136:139], v[160:163]
  ds_read_b128 v[30:33], v13 offset:4096
  s_waitcnt lgkmcnt(4)
  v_mfma_f32_16x16x32_bf16 v[144:147], v[14:17], v[140:143], v[144:147]
  ds_read_b128 v[14:17], v9 offset:0
  s_waitcnt lgkmcnt(4)
  v_mfma_f32_16x16x32_bf16 v[148:151], v[18:21], v[140:143], v[148:151]
  ds_read_b128 v[18:21], v9 offset:1024
  s_waitcnt lgkmcnt(4)
  v_mfma_f32_16x16x32_bf16 v[152:155], v[22:25], v[140:143], v[152:155]
  ds_read_b128 v[22:25], v9 offset:2048
  s_waitcnt lgkmcnt(4)
  v_mfma_f32_16x16x32_bf16 v[156:159], v[26:29], v[140:143], v[156:159]
  ds_read_b128 v[26:29], v9 offset:3072
  s_waitcnt lgkmcnt(4)
  v_mfma_f32_16x16x32_bf16 v[160:163], v[30:33], v[140:143], v[160:163]
  ds_read_b128 v[30:33], v9 offset:4096
  s_waitcnt vmcnt(12)
attn_kernel_ock0:
  v_max_u32 v62, v64, v65
  v_max_u32 v63, v66, v67
  v_max3_u32 v62, v62, v68, v69
  v_max3_u32 v63, v63, v70, v71
  v_max3_u32 v62, v62, v72, v73
  v_max3_u32 v63, v63, v74, v75
  v_max3_u32 v62, v62, v76, v77
  v_max3_u32 v63, v63, v78, v79
  v_max_u32 v62, v62, v63
  v_cmp_eq_u32 vcc, -1, v62
  s_cbranch_vccz attn_kernel_ook0
  s_add_u32 s55, s55, 1
  s_cmp_gt_u32 s55, 0x20000
  s_cbranch_scc1 attn_kernel_ook0
  s_waitcnt vmcnt(0)
  s_sleep 4
  v_max3_u32 v62, v64, v65, v66
  v_max_u32 v62, v62, v67
  v_cmp_eq_u32 vcc, -1, v62
  s_cbranch_vccz attn_kernel_ors0_0
  s_add_u32 s54, s56, 0
  buffer_load_dwordx4 v[64:67], v2, s[8:11], s54 offen offset:0 sc1
attn_kernel_ors0_0:
  v_max3_u32 v62, v68, v69, v70
  v_max_u32 v62, v62, v71
  v_cmp_eq_u32 vcc, -1, v62
  s_cbranch_vccz attn_kernel_ors0_1
  s_add_u32 s54, s56, 0
  buffer_load_dwordx4 v[68:71], v2, s[8:11], s54 offen offset:1024 sc1
attn_kernel_ors0_1:
  v_max3_u32 v62, v72, v73, v74
  v_max_u32 v62, v62, v75
  v_cmp_eq_u32 vcc, -1, v62
  s_cbranch_vccz attn_kernel_ors0_2
  s_add_u32 s54, s56, 0
  buffer_load_dwordx4 v[72:75], v2, s[8:11], s54 offen offset:2048 sc1
attn_kernel_ors0_2:
  v_max3_u32 v62, v76, v77, v78
  v_max_u32 v62, v62, v79
  v_cmp_eq_u32 vcc, -1, v62
  s_cbranch_vccz attn_kernel_ors0_3
  s_add_u32 s54, s56, 0
  buffer_load_dwordx4 v[76:79], v2, s[8:11], s54 offen offset:3072 sc1
attn_kernel_ors0_3:
  v_max3_u32 v62, v80, v81, v82
  v_max_u32 v62, v62, v83
  v_cmp_eq_u32 vcc, -1, v62
  s_cbranch_vccz attn_kernel_ors0_4
  s_add_u32 s54, s56, 4096
  buffer_load_dwordx4 v[80:83], v2, s[8:11], s54 offen offset:0 sc1
attn_kernel_ors0_4:
  v_max3_u32 v62, v84, v85, v86
  v_max_u32 v62, v62, v87
  v_cmp_eq_u32 vcc, -1, v62
  s_cbranch_vccz attn_kernel_ors0_5
  s_add_u32 s54, s56, 4096
  buffer_load_dwordx4 v[84:87], v2, s[8:11], s54 offen offset:1024 sc1
attn_kernel_ors0_5:
  v_max3_u32 v62, v88, v89, v90
  v_max_u32 v62, v62, v91
  v_cmp_eq_u32 vcc, -1, v62
  s_cbranch_vccz attn_kernel_ors0_6
  s_add_u32 s54, s56, 4096
  buffer_load_dwordx4 v[88:91], v2, s[8:11], s54 offen offset:2048 sc1
attn_kernel_ors0_6:
  v_max3_u32 v62, v92, v93, v94
  v_max_u32 v62, v62, v95
  v_cmp_eq_u32 vcc, -1, v62
  s_cbranch_vccz attn_kernel_ors0_7
  s_add_u32 s54, s56, 4096
  buffer_load_dwordx4 v[92:95], v2, s[8:11], s54 offen offset:3072 sc1
attn_kernel_ors0_7:
  v_max3_u32 v62, v96, v97, v98
  v_max_u32 v62, v62, v99
  v_cmp_eq_u32 vcc, -1, v62
  s_cbranch_vccz attn_kernel_ors0_8
  s_add_u32 s54, s56, 8192
  buffer_load_dwordx4 v[96:99], v2, s[8:11], s54 offen offset:0 sc1
attn_kernel_ors0_8:
  v_max3_u32 v62, v100, v101, v102
  v_max_u32 v62, v62, v103
  v_cmp_eq_u32 vcc, -1, v62
  s_cbranch_vccz attn_kernel_ors0_9
  s_add_u32 s54, s56, 8192
  buffer_load_dwordx4 v[100:103], v2, s[8:11], s54 offen offset:1024 sc1
attn_kernel_ors0_9:
  v_max3_u32 v62, v104, v105, v106
  v_max_u32 v62, v62, v107
  v_cmp_eq_u32 vcc, -1, v62
  s_cbranch_vccz attn_kernel_ors0_10
  s_add_u32 s54, s56, 8192
  buffer_load_dwordx4 v[104:107], v2, s[8:11], s54 offen offset:2048 sc1
attn_kernel_ors0_10:
  v_max3_u32 v62, v108, v109, v110
  v_max_u32 v62, v62, v111
  v_cmp_eq_u32 vcc, -1, v62
  s_cbranch_vccz attn_kernel_ors0_11
  s_add_u32 s54, s56, 8192
  buffer_load_dwordx4 v[108:111], v2, s[8:11], s54 offen offset:3072 sc1
attn_kernel_ors0_11:
  v_max3_u32 v62, v112, v113, v114
  v_max_u32 v62, v62, v115
  v_cmp_eq_u32 vcc, -1, v62
  s_cbranch_vccz attn_kernel_ors0_12
  s_add_u32 s54, s56, 12288
  buffer_load_dwordx4 v[112:115], v2, s[8:11], s54 offen offset:0 sc1
attn_kernel_ors0_12:
  v_max3_u32 v62, v116, v117, v118
  v_max_u32 v62, v62, v119
  v_cmp_eq_u32 vcc, -1, v62
  s_cbranch_vccz attn_kernel_ors0_13
  s_add_u32 s54, s56, 12288
  buffer_load_dwordx4 v[116:119], v2, s[8:11], s54 offen offset:1024 sc1
attn_kernel_ors0_13:
  v_max3_u32 v62, v120, v121, v122
  v_max_u32 v62, v62, v123
  v_cmp_eq_u32 vcc, -1, v62
  s_cbranch_vccz attn_kernel_ors0_14
  s_add_u32 s54, s56, 12288
  buffer_load_dwordx4 v[120:123], v2, s[8:11], s54 offen offset:2048 sc1
attn_kernel_ors0_14:
  v_max3_u32 v62, v124, v125, v126
  v_max_u32 v62, v62, v127
  v_cmp_eq_u32 vcc, -1, v62
  s_cbranch_vccz attn_kernel_ors0_15
  s_add_u32 s54, s56, 12288
  buffer_load_dwordx4 v[124:127], v2, s[8:11], s54 offen offset:3072 sc1
attn_kernel_ors0_15:
  s_waitcnt vmcnt(0)
  s_branch attn_kernel_ock0
attn_kernel_ook0:
  s_waitcnt lgkmcnt(4)
  v_mfma_f32_16x16x32_bf16 v[144:147], v[14:17], v[64:67], v[144:147]
  ds_read_b128 v[14:17], v9 offset:5120
  s_waitcnt lgkmcnt(4)
  v_mfma_f32_16x16x32_bf16 v[148:151], v[18:21], v[64:67], v[148:151]
  ds_read_b128 v[18:21], v9 offset:6144
  s_waitcnt lgkmcnt(4)
  v_mfma_f32_16x16x32_bf16 v[152:155], v[22:25], v[64:67], v[152:155]
  ds_read_b128 v[22:25], v9 offset:7168
  s_waitcnt lgkmcnt(4)
  v_mfma_f32_16x16x32_bf16 v[156:159], v[26:29], v[64:67], v[156:159]
  ds_read_b128 v[26:29], v9 offset:8192
  s_waitcnt lgkmcnt(4)
  v_mfma_f32_16x16x32_bf16 v[160:163], v[30:33], v[64:67], v[160:163]
  ds_read_b128 v[30:33], v9 offset:9216
  s_waitcnt lgkmcnt(4)
  v_mfma_f32_16x16x32_bf16 v[144:147], v[14:17], v[68:71], v[144:147]
  ds_read_b128 v[14:17], v9 offset:10240
  s_waitcnt lgkmcnt(4)
  v_mfma_f32_16x16x32_bf16 v[148:151], v[18:21], v[68:71], v[148:151]
  ds_read_b128 v[18:21], v9 offset:11264
  s_waitcnt lgkmcnt(4)
  v_mfma_f32_16x16x32_bf16 v[152:155], v[22:25], v[68:71], v[152:155]
  ds_read_b128 v[22:25], v9 offset:12288
  s_waitcnt lgkmcnt(4)
  v_mfma_f32_16x16x32_bf16 v[156:159], v[26:29], v[68:71], v[156:159]
  ds_read_b128 v[26:29], v9 offset:13312
  s_waitcnt lgkmcnt(4)
  v_mfma_f32_16x16x32_bf16 v[160:163], v[30:33], v[68:71], v[160:163]
  ds_read_b128 v[30:33], v9 offset:14336
  s_waitcnt lgkmcnt(4)
  v_mfma_f32_16x16x32_bf16 v[144:147], v[14:17], v[72:75], v[144:147]
  ds_read_b128 v[14:17], v9 offset:15360
  s_waitcnt lgkmcnt(4)
  v_mfma_f32_16x16x32_bf16 v[148:151], v[18:21], v[72:75], v[148:151]
  ds_read_b128 v[18:21], v9 offset:16384
  s_waitcnt lgkmcnt(4)
  v_mfma_f32_16x16x32_bf16 v[152:155], v[22:25], v[72:75], v[152:155]
  ds_read_b128 v[22:25], v9 offset:17408
  s_waitcnt lgkmcnt(4)
  v_mfma_f32_16x16x32_bf16 v[156:159], v[26:29], v[72:75], v[156:159]
  ds_read_b128 v[26:29], v9 offset:18432
  s_waitcnt lgkmcnt(4)
  v_mfma_f32_16x16x32_bf16 v[160:163], v[30:33], v[72:75], v[160:163]
  ds_read_b128 v[30:33], v9 offset:19456
  s_waitcnt lgkmcnt(4)
  v_mfma_f32_16x16x32_bf16 v[144:147], v[14:17], v[76:79], v[144:147]
  ds_read_b128 v[14:17], v9 offset:20480
  s_waitcnt lgkmcnt(4)
  v_mfma_f32_16x16x32_bf16 v[148:151], v[18:21], v[76:79], v[148:151]
  ds_read_b128 v[18:21], v9 offset:21504
  s_waitcnt lgkmcnt(4)
  v_mfma_f32_16x16x32_bf16 v[152:155], v[22:25], v[76:79], v[152:155]
  ds_read_b128 v[22:25], v9 offset:22528
  s_waitcnt lgkmcnt(4)
  v_mfma_f32_16x16x32_bf16 v[156:159], v[26:29], v[76:79], v[156:159]
  ds_read_b128 v[26:29], v9 offset:23552
  s_waitcnt lgkmcnt(4)
  v_mfma_f32_16x16x32_bf16 v[160:163], v[30:33], v[76:79], v[160:163]
  ds_read_b128 v[30:33], v9 offset:24576
  s_waitcnt vmcnt(7)
attn_kernel_ock4:
  v_max_u32 v62, v80, v81
  v_max_u32 v63, v82, v83
  v_max3_u32 v62, v62, v84, v85
  v_max3_u32 v63, v63, v86, v87
  v_max3_u32 v62, v62, v88, v89
  v_max3_u32 v63, v63, v90, v91
  v_max3_u32 v62, v62, v92, v93
  v_max3_u32 v63, v63, v94, v95
  v_max3_u32 v62, v62, v96, v97
  v_max3_u32 v63, v63, v98, v99
  v_max_u32 v62, v62, v63
  v_cmp_eq_u32 vcc, -1, v62
  s_cbranch_vccz attn_kernel_ook4
  s_add_u32 s55, s55, 1
  s_cmp_gt_u32 s55, 0x20000
  s_cbranch_scc1 attn_kernel_ook4
  s_waitcnt vmcnt(0)
  s_sleep 4
  v_max3_u32 v62, v80, v81, v82
  v_max_u32 v62, v62, v83
  v_cmp_eq_u32 vcc, -1, v62
  s_cbranch_vccz attn_kernel_ors4_4
  s_add_u32 s54, s56, 4096
  buffer_load_dwordx4 v[80:83], v2, s[8:11], s54 offen offset:0 sc1
attn_kernel_ors4_4:
  v_max3_u32 v62, v84, v85, v86
  v_max_u32 v62, v62, v87
  v_cmp_eq_u32 vcc, -1, v62
  s_cbranch_vccz attn_kernel_ors4_5
  s_add_u32 s54, s56, 4096
  buffer_load_dwordx4 v[84:87], v2, s[8:11], s54 offen offset:1024 sc1
attn_kernel_ors4_5:
  v_max3_u32 v62, v88, v89, v90
  v_max_u32 v62, v62, v91
  v_cmp_eq_u32 vcc, -1, v62
  s_cbranch_vccz attn_kernel_ors4_6
  s_add_u32 s54, s56, 4096
  buffer_load_dwordx4 v[88:91], v2, s[8:11], s54 offen offset:2048 sc1
attn_kernel_ors4_6:
  v_max3_u32 v62, v92, v93, v94
  v_max_u32 v62, v62, v95
  v_cmp_eq_u32 vcc, -1, v62
  s_cbranch_vccz attn_kernel_ors4_7
  s_add_u32 s54, s56, 4096
  buffer_load_dwordx4 v[92:95], v2, s[8:11], s54 offen offset:3072 sc1
attn_kernel_ors4_7:
  v_max3_u32 v62, v96, v97, v98
  v_max_u32 v62, v62, v99
  v_cmp_eq_u32 vcc, -1, v62
  s_cbranch_vccz attn_kernel_ors4_8
  s_add_u32 s54, s56, 8192
  buffer_load_dwordx4 v[96:99], v2, s[8:11], s54 offen offset:0 sc1
attn_kernel_ors4_8:
  v_max3_u32 v62, v100, v101, v102
  v_max_u32 v62, v62, v103
  v_cmp_eq_u32 vcc, -1, v62
  s_cbranch_vccz attn_kernel_ors4_9
  s_add_u32 s54, s56, 8192
  buffer_load_dwordx4 v[100:103], v2, s[8:11], s54 offen offset:1024 sc1
attn_kernel_ors4_9:
  v_max3_u32 v62, v104, v105, v106
  v_max_u32 v62, v62, v107
  v_cmp_eq_u32 vcc, -1, v62
  s_cbranch_vccz attn_kernel_ors4_10
  s_add_u32 s54, s56, 8192
  buffer_load_dwordx4 v[104:107], v2, s[8:11], s54 offen offset:2048 sc1
attn_kernel_ors4_10:
  v_max3_u32 v62, v108, v109, v110
  v_max_u32 v62, v62, v111
  v_cmp_eq_u32 vcc, -1, v62
  s_cbranch_vccz attn_kernel_ors4_11
  s_add_u32 s54, s56, 8192
  buffer_load_dwordx4 v[108:111], v2, s[8:11], s54 offen offset:3072 sc1
attn_kernel_ors4_11:
  v_max3_u32 v62, v112, v113, v114
  v_max_u32 v62, v62, v115
  v_cmp_eq_u32 vcc, -1, v62
  s_cbranch_vccz attn_kernel_ors4_12
  s_add_u32 s54, s56, 12288
  buffer_load_dwordx4 v[112:115], v2, s[8:11], s54 offen offset:0 sc1
attn_kernel_ors4_12:
  v_max3_u32 v62, v116, v117, v118
  v_max_u32 v62, v62, v119
  v_cmp_eq_u32 vcc, -1, v62
  s_cbranch_vccz attn_kernel_ors4_13
  s_add_u32 s54, s56, 12288
  buffer_load_dwordx4 v[116:119], v2, s[8:11], s54 offen offset:1024 sc1
attn_kernel_ors4_13:
  v_max3_u32 v62, v120, v121, v122
  v_max_u32 v62, v62, v123
  v_cmp_eq_u32 vcc, -1, v62
  s_cbranch_vccz attn_kernel_ors4_14
  s_add_u32 s54, s56, 12288
  buffer_load_dwordx4 v[120:123], v2, s[8:11], s54 offen offset:2048 sc1
attn_kernel_ors4_14:
  v_max3_u32 v62, v124, v125, v126
  v_max_u32 v62, v62, v127
  v_cmp_eq_u32 vcc, -1, v62
  s_cbranch_vccz attn_kernel_ors4_15
  s_add_u32 s54, s56, 12288
  buffer_load_dwordx4 v[124:127], v2, s[8:11], s54 offen offset:3072 sc1
attn_kernel_ors4_15:
  s_waitcnt vmcnt(0)
  s_branch attn_kernel_ock4
attn_kernel_ook4:
  s_waitcnt lgkmcnt(4)
  v_mfma_f32_16x16x32_bf16 v[144:147], v[14:17], v[80:83], v[144:147]
  ds_read_b128 v[14:17], v9 offset:25600
  s_waitcnt lgkmcnt(4)
  v_mfma_f32_16x16x32_bf16 v[148:151], v[18:21], v[80:83], v[148:151]
  ds_read_b128 v[18:21], v9 offset:26624
  s_waitcnt lgkmcnt(4)
  v_mfma_f32_16x16x32_bf16 v[152:155], v[22:25], v[80:83], v[152:155]
  ds_read_b128 v[22:25], v9 offset:27648
  s_waitcnt lgkmcnt(4)
  v_mfma_f32_16x16x32_bf16 v[156:159], v[26:29], v[80:83], v[156:159]
  ds_read_b128 v[26:29], v9 offset:28672
  s_waitcnt lgkmcnt(4)
  v_mfma_f32_16x16x32_bf16 v[160:163], v[30:33], v[80:83], v[160:163]
  ds_read_b128 v[30:33], v9 offset:29696
  s_waitcnt lgkmcnt(4)
  v_mfma_f32_16x16x32_bf16 v[144:147], v[14:17], v[84:87], v[144:147]
  ds_read_b128 v[14:17], v9 offset:30720
  s_waitcnt lgkmcnt(4)
  v_mfma_f32_16x16x32_bf16 v[148:151], v[18:21], v[84:87], v[148:151]
  ds_read_b128 v[18:21], v9 offset:31744
  s_waitcnt lgkmcnt(4)
  v_mfma_f32_16x16x32_bf16 v[152:155], v[22:25], v[84:87], v[152:155]
  ds_read_b128 v[22:25], v9 offset:32768
  s_waitcnt lgkmcnt(4)
  v_mfma_f32_16x16x32_bf16 v[156:159], v[26:29], v[84:87], v[156:159]
  ds_read_b128 v[26:29], v9 offset:33792
  s_waitcnt lgkmcnt(4)
  v_mfma_f32_16x16x32_bf16 v[160:163], v[30:33], v[84:87], v[160:163]
  ds_read_b128 v[30:33], v9 offset:34816
  s_waitcnt lgkmcnt(4)
  v_mfma_f32_16x16x32_bf16 v[144:147], v[14:17], v[88:91], v[144:147]
  ds_read_b128 v[14:17], v9 offset:35840
  s_waitcnt lgkmcnt(4)
  v_mfma_f32_16x16x32_bf16 v[148:151], v[18:21], v[88:91], v[148:151]
  ds_read_b128 v[18:21], v9 offset:36864
  s_waitcnt lgkmcnt(4)
  v_mfma_f32_16x16x32_bf16 v[152:155], v[22:25], v[88:91], v[152:155]
  ds_read_b128 v[22:25], v9 offset:37888
  s_waitcnt lgkmcnt(4)
  v_mfma_f32_16x16x32_bf16 v[156:159], v[26:29], v[88:91], v[156:159]
  ds_read_b128 v[26:29], v9 offset:38912
  s_waitcnt lgkmcnt(4)
  v_mfma_f32_16x16x32_bf16 v[160:163], v[30:33], v[88:91], v[160:163]
  ds_read_b128 v[30:33], v9 offset:39936
  s_waitcnt lgkmcnt(4)
  v_mfma_f32_16x16x32_bf16 v[144:147], v[14:17], v[92:95], v[144:147]
  ds_read_b128 v[14:17], v9 offset:40960
  s_waitcnt lgkmcnt(4)
  v_mfma_f32_16x16x32_bf16 v[148:151], v[18:21], v[92:95], v[148:151]
  ds_read_b128 v[18:21], v9 offset:41984
  s_waitcnt lgkmcnt(4)
  v_mfma_f32_16x16x32_bf16 v[152:155], v[22:25], v[92:95], v[152:155]
  ds_read_b128 v[22:25], v9 offset:43008
  s_waitcnt lgkmcnt(4)
  v_mfma_f32_16x16x32_bf16 v[156:159], v[26:29], v[92:95], v[156:159]
  ds_read_b128 v[26:29], v9 offset:44032
  s_waitcnt lgkmcnt(4)
  v_mfma_f32_16x16x32_bf16 v[160:163], v[30:33], v[92:95], v[160:163]
  ds_read_b128 v[30:33], v9 offset:45056
  s_waitcnt lgkmcnt(4)
  v_mfma_f32_16x16x32_bf16 v[144:147], v[14:17], v[96:99], v[144:147]
  ds_read_b128 v[14:17], v9 offset:46080
  s_waitcnt lgkmcnt(4)
  v_mfma_f32_16x16x32_bf16 v[148:151], v[18:21], v[96:99], v[148:151]
  ds_read_b128 v[18:21], v9 offset:47104
  s_waitcnt lgkmcnt(4)
  v_mfma_f32_16x16x32_bf16 v[152:155], v[22:25], v[96:99], v[152:155]
  ds_read_b128 v[22:25], v9 offset:48128
  s_waitcnt lgkmcnt(4)
  v_mfma_f32_16x16x32_bf16 v[156:159], v[26:29], v[96:99], v[156:159]
  ds_read_b128 v[26:29], v9 offset:49152
  s_waitcnt lgkmcnt(4)
  v_mfma_f32_16x16x32_bf16 v[160:163], v[30:33], v[96:99], v[160:163]
  ds_read_b128 v[30:33], v9 offset:50176
  s_waitcnt vmcnt(0)
attn_kernel_ock9:
  v_max_u32 v62, v100, v101
  v_max_u32 v63, v102, v103
  v_max3_u32 v62, v62, v104, v105
  v_max3_u32 v63, v63, v106, v107
  v_max3_u32 v62, v62, v108, v109
  v_max3_u32 v63, v63, v110, v111
  v_max3_u32 v62, v62, v112, v113
  v_max3_u32 v63, v63, v114, v115
  v_max3_u32 v62, v62, v116, v117
  v_max3_u32 v63, v63, v118, v119
  v_max3_u32 v62, v62, v120, v121
  v_max3_u32 v63, v63, v122, v123
  v_max3_u32 v62, v62, v124, v125
  v_max3_u32 v63, v63, v126, v127
  v_max_u32 v62, v62, v63
  v_cmp_eq_u32 vcc, -1, v62
  s_cbranch_vccz attn_kernel_ook9
  s_add_u32 s55, s55, 1
  s_cmp_gt_u32 s55, 0x20000
  s_cbranch_scc1 attn_kernel_ook9
  s_waitcnt vmcnt(0)
  s_sleep 4
  v_max3_u32 v62, v100, v101, v102
  v_max_u32 v62, v62, v103
  v_cmp_eq_u32 vcc, -1, v62
  s_cbranch_vccz attn_kernel_ors9_9
  s_add_u32 s54, s56, 8192
  buffer_load_dwordx4 v[100:103], v2, s[8:11], s54 offen offset:1024 sc1
attn_kernel_ors9_9:
  v_max3_u32 v62, v104, v105, v106
  v_max_u32 v62, v62, v107
  v_cmp_eq_u32 vcc, -1, v62
  s_cbranch_vccz attn_kernel_ors9_10
  s_add_u32 s54, s56, 8192
  buffer_load_dwordx4 v[104:107], v2, s[8:11], s54 offen offset:2048 sc1
attn_kernel_ors9_10:
  v_max3_u32 v62, v108, v109, v110
  v_max_u32 v62, v62, v111
  v_cmp_eq_u32 vcc, -1, v62
  s_cbranch_vccz attn_kernel_ors9_11
  s_add_u32 s54, s56, 8192
  buffer_load_dwordx4 v[108:111], v2, s[8:11], s54 offen offset:3072 sc1
attn_kernel_ors9_11:
  v_max3_u32 v62, v112, v113, v114
  v_max_u32 v62, v62, v115
  v_cmp_eq_u32 vcc, -1, v62
  s_cbranch_vccz attn_kernel_ors9_12
  s_add_u32 s54, s56, 12288
  buffer_load_dwordx4 v[112:115], v2, s[8:11], s54 offen offset:0 sc1
attn_kernel_ors9_12:
  v_max3_u32 v62, v116, v117, v118
  v_max_u32 v62, v62, v119
  v_cmp_eq_u32 vcc, -1, v62
  s_cbranch_vccz attn_kernel_ors9_13
  s_add_u32 s54, s56, 12288
  buffer_load_dwordx4 v[116:119], v2, s[8:11], s54 offen offset:1024 sc1
attn_kernel_ors9_13:
  v_max3_u32 v62, v120, v121, v122
  v_max_u32 v62, v62, v123
  v_cmp_eq_u32 vcc, -1, v62
  s_cbranch_vccz attn_kernel_ors9_14
  s_add_u32 s54, s56, 12288
  buffer_load_dwordx4 v[120:123], v2, s[8:11], s54 offen offset:2048 sc1
attn_kernel_ors9_14:
  v_max3_u32 v62, v124, v125, v126
  v_max_u32 v62, v62, v127
  v_cmp_eq_u32 vcc, -1, v62
  s_cbranch_vccz attn_kernel_ors9_15
  s_add_u32 s54, s56, 12288
  buffer_load_dwordx4 v[124:127], v2, s[8:11], s54 offen offset:3072 sc1
attn_kernel_ors9_15:
  s_waitcnt vmcnt(0)
  s_branch attn_kernel_ock9
attn_kernel_ook9:
  s_waitcnt lgkmcnt(4)
  v_mfma_f32_16x16x32_bf16 v[144:147], v[14:17], v[100:103], v[144:147]
  ds_read_b128 v[14:17], v10 offset:0
  s_waitcnt lgkmcnt(4)
  v_mfma_f32_16x16x32_bf16 v[148:151], v[18:21], v[100:103], v[148:151]
  ds_read_b128 v[18:21], v10 offset:1024
  s_waitcnt lgkmcnt(4)
  v_mfma_f32_16x16x32_bf16 v[152:155], v[22:25], v[100:103], v[152:155]
  ds_read_b128 v[22:25], v10 offset:2048
  s_waitcnt lgkmcnt(4)
  v_mfma_f32_16x16x32_bf16 v[156:159], v[26:29], v[100:103], v[156:159]
  ds_read_b128 v[26:29], v10 offset:3072
  s_waitcnt lgkmcnt(4)
  v_mfma_f32_16x16x32_bf16 v[160:163], v[30:33], v[100:103], v[160:163]
  ds_read_b128 v[30:33], v10 offset:4096
  s_waitcnt lgkmcnt(4)
  v_mfma_f32_16x16x32_bf16 v[144:147], v[14:17], v[104:107], v[144:147]
  ds_read_b128 v[14:17], v10 offset:5120
  s_waitcnt lgkmcnt(4)
  v_mfma_f32_16x16x32_bf16 v[148:151], v[18:21], v[104:107], v[148:151]
  ds_read_b128 v[18:21], v10 offset:6144
  s_waitcnt lgkmcnt(4)
  v_mfma_f32_16x16x32_bf16 v[152:155], v[22:25], v[104:107], v[152:155]
  ds_read_b128 v[22:25], v10 offset:7168
  s_waitcnt lgkmcnt(4)
  v_mfma_f32_16x16x32_bf16 v[156:159], v[26:29], v[104:107], v[156:159]
  ds_read_b128 v[26:29], v10 offset:8192
  s_waitcnt lgkmcnt(4)
  v_mfma_f32_16x16x32_bf16 v[160:163], v[30:33], v[104:107], v[160:163]
  ds_read_b128 v[30:33], v10 offset:9216
  s_waitcnt lgkmcnt(4)
  v_mfma_f32_16x16x32_bf16 v[144:147], v[14:17], v[108:111], v[144:147]
  ds_read_b128 v[14:17], v10 offset:10240
  s_waitcnt lgkmcnt(4)
  v_mfma_f32_16x16x32_bf16 v[148:151], v[18:21], v[108:111], v[148:151]
  ds_read_b128 v[18:21], v10 offset:11264
  s_waitcnt lgkmcnt(4)
  v_mfma_f32_16x16x32_bf16 v[152:155], v[22:25], v[108:111], v[152:155]
  ds_read_b128 v[22:25], v10 offset:12288
  s_waitcnt lgkmcnt(4)
  v_mfma_f32_16x16x32_bf16 v[156:159], v[26:29], v[108:111], v[156:159]
  ds_read_b128 v[26:29], v10 offset:13312
  s_waitcnt lgkmcnt(4)
  v_mfma_f32_16x16x32_bf16 v[160:163], v[30:33], v[108:111], v[160:163]
  ds_read_b128 v[30:33], v10 offset:14336
  s_waitcnt lgkmcnt(4)
  v_mfma_f32_16x16x32_bf16 v[144:147], v[14:17], v[112:115], v[144:147]
  ds_read_b128 v[14:17], v10 offset:15360
  s_waitcnt lgkmcnt(4)
  v_mfma_f32_16x16x32_bf16 v[148:151], v[18:21], v[112:115], v[148:151]
  ds_read_b128 v[18:21], v10 offset:16384
  s_waitcnt lgkmcnt(4)
  v_mfma_f32_16x16x32_bf16 v[152:155], v[22:25], v[112:115], v[152:155]
  ds_read_b128 v[22:25], v10 offset:17408
  s_waitcnt lgkmcnt(4)
  v_mfma_f32_16x16x32_bf16 v[156:159], v[26:29], v[112:115], v[156:159]
  ds_read_b128 v[26:29], v10 offset:18432
  s_waitcnt lgkmcnt(4)
  v_mfma_f32_16x16x32_bf16 v[160:163], v[30:33], v[112:115], v[160:163]
  ds_read_b128 v[30:33], v10 offset:19456
  s_waitcnt lgkmcnt(4)
  v_mfma_f32_16x16x32_bf16 v[144:147], v[14:17], v[116:119], v[144:147]
  ds_read_b128 v[14:17], v10 offset:20480
  s_waitcnt lgkmcnt(4)
  v_mfma_f32_16x16x32_bf16 v[148:151], v[18:21], v[116:119], v[148:151]
  ds_read_b128 v[18:21], v10 offset:21504
  s_waitcnt lgkmcnt(4)
  v_mfma_f32_16x16x32_bf16 v[152:155], v[22:25], v[116:119], v[152:155]
  ds_read_b128 v[22:25], v10 offset:22528
  s_waitcnt lgkmcnt(4)
  v_mfma_f32_16x16x32_bf16 v[156:159], v[26:29], v[116:119], v[156:159]
  ds_read_b128 v[26:29], v10 offset:23552
  s_waitcnt lgkmcnt(4)
  v_mfma_f32_16x16x32_bf16 v[160:163], v[30:33], v[116:119], v[160:163]
  ds_read_b128 v[30:33], v10 offset:24576
  s_waitcnt lgkmcnt(4)
  v_mfma_f32_16x16x32_bf16 v[144:147], v[14:17], v[120:123], v[144:147]
  ds_read_b128 v[14:17], v10 offset:25600
  s_waitcnt lgkmcnt(4)
  v_mfma_f32_16x16x32_bf16 v[148:151], v[18:21], v[120:123], v[148:151]
  ds_read_b128 v[18:21], v10 offset:26624
  s_waitcnt lgkmcnt(4)
  v_mfma_f32_16x16x32_bf16 v[152:155], v[22:25], v[120:123], v[152:155]
  ds_read_b128 v[22:25], v10 offset:27648
  s_waitcnt lgkmcnt(4)
  v_mfma_f32_16x16x32_bf16 v[156:159], v[26:29], v[120:123], v[156:159]
  ds_read_b128 v[26:29], v10 offset:28672
  s_waitcnt lgkmcnt(4)
  v_mfma_f32_16x16x32_bf16 v[160:163], v[30:33], v[120:123], v[160:163]
  ds_read_b128 v[30:33], v10 offset:29696
  s_waitcnt lgkmcnt(4)
  v_mfma_f32_16x16x32_bf16 v[144:147], v[14:17], v[124:127], v[144:147]
  s_waitcnt lgkmcnt(3)
  v_mfma_f32_16x16x32_bf16 v[148:151], v[18:21], v[124:127], v[148:151]
  s_waitcnt lgkmcnt(2)
  v_mfma_f32_16x16x32_bf16 v[152:155], v[22:25], v[124:127], v[152:155]
  s_waitcnt lgkmcnt(1)
  v_mfma_f32_16x16x32_bf16 v[156:159], v[26:29], v[124:127], v[156:159]
  s_waitcnt lgkmcnt(0)
  v_mfma_f32_16x16x32_bf16 v[160:163], v[30:33], v[124:127], v[160:163]
  v_fmac_f32 v50, v144, v44
  v_fmac_f32 v51, v145, v44
  v_fmac_f32 v52, v146, v44
  v_fmac_f32 v53, v147, v44
  v_cvt_pk_bf16_f32 v84, v50, v51
  v_cvt_pk_bf16_f32 v85, v52, v53
  buffer_store_dwordx2 v[84:85], v12, s[24:27], s50 offen offset:0
  v_fmac_f32 v54, v148, v44
  v_fmac_f32 v55, v149, v44
  v_fmac_f32 v56, v150, v44
  v_fmac_f32 v57, v151, v44
  v_cvt_pk_bf16_f32 v86, v54, v55
  v_cvt_pk_bf16_f32 v87, v56, v57
  buffer_store_dwordx2 v[86:87], v12, s[24:27], s50 offen offset:32
  v_fmac_f32 v58, v152, v44
  v_fmac_f32 v59, v153, v44
  v_fmac_f32 v34, v154, v44
  v_fmac_f32 v35, v155, v44
  v_cvt_pk_bf16_f32 v88, v58, v59
  v_cvt_pk_bf16_f32 v89, v34, v35
  buffer_store_dwordx2 v[88:89], v12, s[24:27], s50 offen offset:64
  v_fmac_f32 v36, v156, v44
  v_fmac_f32 v37, v157, v44
  v_fmac_f32 v38, v158, v44
  v_fmac_f32 v39, v159, v44
  v_cvt_pk_bf16_f32 v90, v36, v37
  v_cvt_pk_bf16_f32 v91, v38, v39
  buffer_store_dwordx2 v[90:91], v12, s[24:27], s50 offen offset:96
  v_fmac_f32 v40, v160, v44
  v_fmac_f32 v41, v161, v44
  v_fmac_f32 v42, v162, v44
  v_fmac_f32 v43, v163, v44
  v_cvt_pk_bf16_f32 v92, v40, v41
  v_cvt_pk_bf16_f32 v93, v42, v43
  buffer_store_dwordx2 v[92:93], v12, s[24:27], s50 offen offset:128
attn_kernel_end:
  s_endpgm

.section .rodata,"a"
.p2align 6
.amdhsa_kernel proj_kernel
  .amdhsa_next_free_vgpr 128
  .amdhsa_next_free_sgpr 78
  .amdhsa_accum_offset 128
  .amdhsa_group_segment_fixed_size 0
  .amdhsa_kernarg_size 104
  .amdhsa_user_sgpr_count 2
  .amdhsa_user_sgpr_kernarg_segment_ptr 1
  .amdhsa_system_sgpr_workgroup_id_x 1
  .amdhsa_float_denorm_mode_32 3
.end_amdhsa_kernel

.p2align 6
.amdhsa_kernel attn_kernel
  .amdhsa_next_free_vgpr 164
  .amdhsa_next_free_sgpr 78
  .amdhsa_accum_offset 164
  .amdhsa_group_segment_fixed_size 0
  .amdhsa_kernarg_size 104
  .amdhsa_user_sgpr_count 2
  .amdhsa_user_sgpr_kernarg_segment_ptr 1
  .amdhsa_system_sgpr_workgroup_id_x 1
  .amdhsa_float_denorm_mode_32 3
.end_amdhsa_kernel
```
